```python
import torch

def _softmax(x, axis=-1):
    return torch.softmax(x, dim=axis)
def _gelu(x):
    return torch.nn.functional.gelu(x, approximate="tanh")
def _silu(x):
    return torch.nn.functional.silu(x)
def _sigmoid(x):
    return torch.sigmoid(x)
def _layernorm(x, axis=-1, eps=1e-5):
    m = x.mean(dim=axis, keepdim=True)
    v = x.var(dim=axis, keepdim=True, unbiased=False)
    return (x - m) / torch.sqrt(v + eps)
def _scatter_add(tgt, idx, src, axis=0):
    return tgt.clone().index_add_(axis, idx, src)
def _segment_sum(src, seg, n):
    out = torch.zeros((n,) + src.shape[1:], dtype=src.dtype)
    return out.index_add_(0, seg, src)
def _pad(x, pw):
    flat = tuple(v for pair in reversed(pw) for v in pair)
    return torch.nn.functional.pad(x, flat)

kernel_name = 'gated_mix__ssm_conv_s4d__geglu_ffn__prompt'

def setup_inputs():

    _w = (lambda a: (lambda t: t.to(torch.bfloat16) if t.is_floating_point() else t)(torch.as_tensor(a)))
    def _A_setup():
        Bsz, L, D, N = 1, 2048, 640, 192
        return {
            "u": _w((lambda *s: torch.randn(*s, dtype=torch.bfloat16) * 0.05)(Bsz, L, D)),
            "log_A_real": _w((lambda *s: torch.randn(*s, dtype=torch.bfloat16) * 6.4)(D, N) * 0.5),
            "A_imag": _w((lambda *s: torch.randn(*s, dtype=torch.bfloat16) * 0.05)(D, N) * 3.14),
            "C_real": _w((lambda *s: torch.randn(*s, dtype=torch.bfloat16) * 0.05)(D, N) / N ** 0.5),
            "C_imag": _w((lambda *s: torch.randn(*s, dtype=torch.bfloat16) * 0.05)(D, N) / N ** 0.5),
            "log_dt": _w((lambda *s: torch.randn(*s, dtype=torch.bfloat16) * 0.05)(D) * 0.5 - 4.0),
            "D_skip": _w((lambda *s: torch.randn(*s, dtype=torch.bfloat16) * 0.05)(D)),
        }
    _A_in = _A_setup()

    def _B_setup():
        B, S, D, F = 1, 2048, 640, 1536
        return {
            "x": _w((lambda *s: torch.randn(*s, dtype=torch.bfloat16) * 0.05)(B, S, D)),
            "w_gate": _w((lambda *s: torch.randn(*s, dtype=torch.bfloat16) * 0.05)(D, F)),
            "w_up": _w((lambda *s: torch.randn(*s, dtype=torch.bfloat16) * 0.05)(D, F)),
            "w_down": _w((lambda *s: torch.randn(*s, dtype=torch.bfloat16) * 0.05)(F, D)),
        }
    _B_in = _B_setup()

    return {
        "A_u": _A_in["u"],
        "A_log_A_real": _A_in["log_A_real"],
        "A_A_imag": _A_in["A_imag"],
        "A_C_real": _A_in["C_real"],
        "A_C_imag": _A_in["C_imag"],
        "A_log_dt": _A_in["log_dt"],
        "A_D_skip": _A_in["D_skip"],
        "B_x": _B_in["x"],
        "B_w_gate": _B_in["w_gate"],
        "B_w_up": _B_in["w_up"],
        "B_w_down": _B_in["w_down"],
        "gate_w": _w((lambda *s: torch.randn(*s, dtype=torch.bfloat16) * 0.05)(640) * 16.0),
    }

def reference(A_u, A_log_A_real, A_A_imag, A_C_real, A_C_imag, A_log_dt, A_D_skip, B_x, B_w_gate, B_w_up, B_w_down, gate_w):
    def _A_ref(u, log_A_real, A_imag, C_real, C_imag, log_dt, D_skip):
        L = u.shape[1]
        dt = torch.exp(log_dt)
        A = -torch.exp(log_A_real) + 1j * A_imag
        C = (C_real + 1j * C_imag) * dt[:, None]
        pos = (lambda x, dt: x.to(dt))(torch.arange(L), log_dt.dtype)
        P = torch.exp((A * dt[:, None])[:, :, None] * pos[None, None, :])
        K = 2.0 * torch.einsum("dn,dnl->dl", C, P).real
        L2 = 2 * L
        u_t = (lambda x, *d: x.permute(*d))(u, 0, 2, 1)
        Kf = (lambda x, *a, **k: torch.fft.rfft(x.float(), *a, **k))(K, L2)
        Uf = (lambda x, *a, **k: torch.fft.rfft(x.float(), *a, **k))(u_t, L2)
        y = (lambda x, *a, **k: torch.fft.irfft(x, *a, **k).to(torch.bfloat16))(Uf * Kf[None, :, :], L2)[:, :, :L]
        y = (lambda x, *d: x.permute(*d))(y, 0, 2, 1)
        return y + u * D_skip[None, None, :]

    def _B_ref(x, w_gate, w_up, w_down):
        return (_gelu(x @ w_gate) * (x @ w_up)) @ w_down

    x = A_u
    g = _sigmoid((x * gate_w).sum(-1, keepdims=True))
    a = _A_ref(x, A_log_A_real, A_A_imag, A_C_real, A_C_imag, A_log_dt, A_D_skip)
    b = _B_ref(x, B_w_gate, B_w_up, B_w_down)
    return g * a + (1 - g) * b
```

```asm
; @launch grid=(512,1,1) block=(256,1,1) lds=81920
.amdgcn_target "amdgcn-amd-amdhsa--gfx950"
.text
.globl gated_mix__ssm_conv_s4d__geglu_ffn__prompt_kernel
.p2align 8
.type gated_mix__ssm_conv_s4d__geglu_ffn__prompt_kernel,@function
gated_mix__ssm_conv_s4d__geglu_ffn__prompt_kernel:
s_load_dwordx16 s[36:51], s[0:1], 0
s_load_dwordx8 s[52:59], s[0:1], 64
s_load_dwordx4 s[60:63], s[0:1], 96
s_load_dwordx2 s[64:65], s[0:1], 112
s_cmp_ge_u32 s2, 512
s_cbranch_scc1 L_exit
v_lshrrev_b32 v1, 6, v0
v_and_b32 v0, 63, v0
v_readfirstlane_b32 s66, v1
s_and_b32 s3, s2, 7
s_bfe_u32 s67, s2, 0x50003
s_lshr_b32 s70, s2, 3
s_lshl_b32 s70, s70, 2
s_add_u32 s70, s70, s66
s_sub_u32 s70, s70, 0
s_cmp_ge_u32 s70, 4
s_cbranch_scc1 L_nocw
s_getpc_b64 s[72:73]
s_and_b32 s72, s72, 0xffffff00
s_lshl_b32 s70, s70, 13
v_lshl_add_u32 v1, v0, 7, s70
v_min_u32 v1, L_end-gated_mix__ssm_conv_s4d__geglu_ffn__prompt_kernel-4, v1
global_load_dword v255, v1, s[72:73]
L_nocw:
s_cmp_lt_u32 s2, 256
s_cbranch_scc1 L_half1
s_cmp_ge_u32 s67, 30
s_cbranch_scc1 L_prepC
s_setprio 2
s_mul_i32 s68, s67, 43
s_lshr_b32 s68, s68, 8
s_mul_i32 s69, s68, 6
s_sub_u32 s69, s67, s69
s_and_b32 s70, s3, 1
s_add_u32 s72, s68, s69
s_lshl_b32 s72, s72, 1
s_add_u32 s72, s72, s70
s_cmp_eq_u32 s69, 5
s_cselect_b32 s12, 0x8000000, 0
s_addc_u32 s72, s72, 0
s_mul_i32 s73, s70, 5
s_add_u32 s73, s73, s68
s_mul_i32 s91, s73, 3072
s_lshr_b32 s71, s3, 1
s_mul_i32 s73, s71, 6
s_add_u32 s69, s69, s73
s_lshl_b32 s73, s69, 7
s_add_u32 s91, s91, s73
s_add_u32 s20, s91, 81920
s_add_u32 s91, s91, 24576
s_mul_i32 s73, s68, 6
s_lshr_b32 s79, 102261191, s73
s_and_b32 s79, s79, 63
s_cmp_eq_u32 s79, 9
s_cselect_b32 s0, s12, 0
s_mul_i32 s14, s68, 5
s_mul_i32 s15, s71, 3
s_add_u32 s14, s14, s15
s_cmp_lg_u32 s0, 0
s_cselect_b32 s72, s14, s72
s_lshr_b32 s68, 441508288, s73
s_and_b32 s68, s68, 63
s_lshl_b32 s70, s70, 5
s_add_u32 s68, s68, s70
s_mul_i32 s70, s72, 205
s_lshr_b32 s70, s70, 11
s_mul_i32 s70, s70, 10
s_sub_u32 s72, s72, s70
s_lshl_b32 s71, s71, 1
s_cmp_ge_u32 s71, s79
s_cselect_b32 s13, 0x8000000, s12
s_cselect_b32 s70, s79, 0
s_sub_u32 s14, s71, s70
s_add_u32 s71, s71, 1
s_cmp_ge_u32 s71, s79
s_cselect_b32 s12, 0x8000000, s12
s_cmp_lg_u32 s0, 0
s_cselect_b32 s14, 8, s14
s_cselect_b32 s13, 0, s13
s_add_u32 s15, s14, 1
s_cmp_eq_u32 s15, s79
s_cselect_b32 s15, 0, s15
s_add_u32 s21, s15, 1
s_cmp_eq_u32 s21, s79
s_cselect_b32 s21, 0, s21
s_mul_i32 s21, s21, 40960
s_mul_i32 s22, s79, 40960
v_lshrrev_b32 v1, 3, v0
v_and_b32 v13, 7, v0
s_lshr_b32 s70, s66, 1
s_lshl_b32 s70, s70, 3
v_add_u32 v16, s70, v1
v_mul_u32_u24 v28, 3072, v16
v_bfe_u32 v17, v0, 4, 1
s_and_b32 s70, s66, 1
s_lshl_b32 s70, s70, 2
v_lshl_or_b32 v17, v17, 1, s70
v_xor_b32 v17, v17, v13
v_lshl_add_u32 v28, v17, 4, v28
s_lshl_b32 s71, s69, 7
v_add_u32 v28, s71, v28
s_lshl_b32 s70, s66, 3
v_add_u32 v29, s70, v1
v_bfe_u32 v17, v29, 1, 3
v_xor_b32 v17, v17, v13
v_mul_u32_u24 v29, 1280, v29
v_lshl_add_u32 v29, v17, 4, v29
s_mul_i32 s73, s68, 40960
v_add_u32 v13, s73, v29
s_mul_i32 s70, s14, 40960
v_add_u32 v29, s70, v13
s_mul_i32 s70, s15, 40960
v_add_u32 v30, s70, v13
s_lshl_b32 s74, s66, 10
s_lshl_b32 s80, s72, 7
s_add_u32 s72, s72, 1
s_cmp_ge_u32 s72, 10
s_cselect_b32 s72, 0, s72
s_lshl_b32 s81, s72, 7
s_add_u32 s72, s72, 1
s_cmp_ge_u32 s72, 10
s_cselect_b32 s72, 0, s72
s_lshl_b32 s82, s72, 7
s_add_u32 s72, s72, 1
s_cmp_ge_u32 s72, 10
s_cselect_b32 s72, 0, s72
s_lshl_b32 s83, s72, 7
s_add_u32 s72, s72, 1
s_cmp_ge_u32 s72, 10
s_cselect_b32 s72, 0, s72
s_lshl_b32 s84, s72, 7
s_add_u32 s72, s72, 1
s_cmp_ge_u32 s72, 10
s_cselect_b32 s72, 0, s72
s_lshl_b32 s85, s72, 7
s_add_u32 s72, s72, 1
s_cmp_ge_u32 s72, 10
s_cselect_b32 s72, 0, s72
s_lshl_b32 s86, s72, 7
s_add_u32 s72, s72, 1
s_cmp_ge_u32 s72, 10
s_cselect_b32 s72, 0, s72
s_lshl_b32 s87, s72, 7
s_add_u32 s72, s72, 1
s_cmp_ge_u32 s72, 10
s_cselect_b32 s72, 0, s72
s_lshl_b32 s88, s72, 7
s_add_u32 s72, s72, 1
s_cmp_ge_u32 s72, 10
s_cselect_b32 s72, 0, s72
s_lshl_b32 s89, s72, 7
s_add_u32 s72, s72, 1
s_cmp_ge_u32 s72, 10
s_cselect_b32 s72, 0, s72
s_mov_b32 s90, 40960
s_sub_u32 s75, s79, 2
v_add_u32 v10, s21, v13
v_bfe_u32 v16, v0, 4, 1
v_lshrrev_b32 v17, 5, v0
v_bfe_u32 v18, v0, 2, 2
v_and_b32 v19, 1, v0
v_bfe_u32 v20, v0, 1, 1
s_lshl_b32 s70, s66, 1
v_or_b32 v19, s70, v19
v_and_b32 v21, 2, v18
v_lshl_or_b32 v21, v16, 2, v21
v_xor_b32 v19, v19, v21
v_lshl_add_u32 v22, v17, 1, v16
v_lshlrev_b32 v14, 10, v22
v_lshl_add_u32 v14, v18, 7, v14
v_lshl_add_u32 v14, v19, 4, v14
v_lshl_add_u32 v14, v20, 3, v14
v_add_u32 v15, s90, v14
v_and_b32 v16, 31, v0
v_bfe_u32 v18, v0, 1, 3
v_xor_b32 v18, v18, v17
v_lshlrev_b32 v2, 7, v16
v_lshl_add_u32 v2, v18, 4, v2
v_xor_b32 v3, 32, v2
v_xor_b32 v4, 64, v2
v_xor_b32 v5, 96, v2
v_add_u32 v6, s90, v2
v_add_u32 v7, s90, v3
v_add_u32 v8, s90, v4
v_add_u32 v9, s90, v5
v_bfe_u32 v18, v0, 4, 1
v_mul_u32_u24 v11, 49152, v18
s_and_b32 s70, s66, 1
s_lshl_b32 s70, s70, 1
v_add_u32 v18, s70, v17
v_lshlrev_b32 v18, 4, v18
v_and_or_b32 v18, v0, 15, v18
v_lshl_add_u32 v11, v18, 4, v11
s_lshl_b32 s78, s69, 1
s_lshr_b32 s70, s66, 1
s_add_u32 s78, s78, s70
s_lshl_b32 s78, s78, 10
s_mul_i32 s70, s68, 98304
s_add_u32 s28, s78, s70
s_mul_i32 s70, s79, 98304
s_add_u32 s29, s28, s70
s_mul_i32 s70, s14, 98304
s_add_u32 s78, s28, s70
v_mov_b32 v12, 0xbdd2d3e8
v_mov_b32 v1, 0
s_mov_b32 s10, 1966080
s_mov_b32 s11, 0x20000
s_mov_b32 s6, 2621440
s_mov_b32 s7, 0x20000
s_mul_i32 s73, s80, 1536
s_mov_b32 m0, s74
s_waitcnt lgkmcnt(0)
s_load_dword s1, s[64:65], 0
s_bitcmp1_b32 s66, 0
s_cselect_b32 s8, s54, s52
s_cselect_b32 s9, s55, s53
buffer_load_dwordx4 v28, s[8:11], s73 offen lds
s_mov_b32 s4, s36
s_mov_b32 s5, s37
s_add_u32 s73, s73, 49152
s_add_u32 m0, s74, 4096
s_nop 0
buffer_load_dwordx4 v28, s[8:11], s73 offen lds
s_add_u32 s73, s73, 49152
s_add_u32 m0, s74, 8192
s_nop 0
buffer_load_dwordx4 v28, s[8:11], s73 offen lds
s_add_u32 s73, s73, 49152
s_add_u32 m0, s74, 12288
s_nop 0
buffer_load_dwordx4 v28, s[8:11], s73 offen lds
s_add_u32 m0, s74, 16384
s_nop 0
buffer_load_dwordx4 v29, s[4:7], s80 offen lds
s_mul_i32 s73, s81, 1536
s_add_u32 m0, s74, 20480
s_nop 0
buffer_load_dwordx4 v28, s[8:11], s73 offen lds
s_add_u32 s16, s64, 1048576
s_addc_u32 s17, s65, 0
s_mov_b32 s18, 6291456
s_mov_b32 s19, 0x20000
s_mov_b32 s24, s64
s_mov_b32 s25, s65
s_mov_b32 s26, 114688
s_mov_b32 s27, 0x20000
s_add_u32 s73, s73, 49152
s_add_u32 m0, s74, 24576
s_nop 0
buffer_load_dwordx4 v28, s[8:11], s73 offen lds
s_add_u32 s73, s73, 49152
s_add_u32 m0, s74, 28672
s_nop 0
buffer_load_dwordx4 v28, s[8:11], s73 offen lds
s_add_u32 s73, s73, 49152
s_add_u32 m0, s74, 32768
s_nop 0
buffer_load_dwordx4 v28, s[8:11], s73 offen lds
s_add_u32 m0, s74, 36864
s_nop 0
buffer_load_dwordx4 v29, s[4:7], s81 offen lds
s_mul_i32 s73, s82, 1536
s_add_u32 m0, s74, 40960
s_nop 0
buffer_load_dwordx4 v28, s[8:11], s73 offen lds
s_add_u32 s73, s73, 49152
s_add_u32 m0, s74, 45056
s_nop 0
buffer_load_dwordx4 v28, s[8:11], s73 offen lds
s_add_u32 s73, s73, 49152
s_add_u32 m0, s74, 49152
s_nop 0
buffer_load_dwordx4 v28, s[8:11], s73 offen lds
s_add_u32 s73, s73, 49152
s_add_u32 m0, s74, 53248
s_nop 0
buffer_load_dwordx4 v28, s[8:11], s73 offen lds
s_add_u32 m0, s74, 57344
s_nop 0
buffer_load_dwordx4 v29, s[4:7], s82 offen lds
s_add_u32 m0, s74, 61440
s_nop 0
buffer_load_dwordx4 v30, s[4:7], s80 offen lds
s_mul_i32 s73, s83, 1536
s_add_u32 m0, s74, 65536
s_nop 0
buffer_load_dwordx4 v28, s[8:11], s73 offen lds
s_add_u32 s73, s73, 49152
s_add_u32 m0, s74, 69632
s_nop 0
buffer_load_dwordx4 v28, s[8:11], s73 offen lds
s_add_u32 s73, s73, 49152
s_add_u32 m0, s74, 73728
s_nop 0
buffer_load_dwordx4 v28, s[8:11], s73 offen lds
s_add_u32 s73, s73, 49152
s_add_u32 m0, s74, 77824
s_nop 0
buffer_load_dwordx4 v28, s[8:11], s73 offen lds
s_add_u32 s32, s64, 16777216
s_addc_u32 s33, s65, 0
s_mov_b32 s34, 2654208
s_mov_b32 s35, 0x20000
v_bfe_u32 v16, v0, 2, 2
s_lshl_b32 s70, s66, 3
v_add_u32 v17, s70, v16
v_bfe_u32 v18, v17, 1, 3
v_lshrrev_b32 v19, 4, v0
v_bfe_u32 v20, v0, 1, 1
v_lshl_or_b32 v19, v19, 1, v20
v_xor_b32 v18, v18, v19
v_lshlrev_b32 v17, 7, v17
v_lshl_add_u32 v17, v18, 4, v17
v_and_b32 v20, 1, v0
v_lshl_add_u32 v18, v20, 3, v17
v_xor_b32 v19, 32, v18
v_add_u32 v19, 512, v19
v_lshlrev_b32 v17, 4, v0
v_add_u32 v20, s74, v17
s_add_u32 s70, s68, s14
s_lshl_b32 s70, s70, 2
s_add_u32 s70, s70, s66
s_mul_i32 s70, s70, 10368
s_add_u32 s70, s70, s13
s_lshl_b32 s71, s80, 3
s_add_u32 s23, s70, s71
s_lshl_b32 s71, s81, 3
s_add_u32 s30, s70, s71
s_add_u32 s70, s68, s15
s_lshl_b32 s70, s70, 2
s_add_u32 s70, s70, s66
s_mul_i32 s70, s70, 10368
s_add_u32 s70, s70, s12
s_lshl_b32 s71, s80, 3
s_add_u32 s31, s70, s71
s_lshl_b32 s71, s81, 3
s_add_u32 s77, s70, s71
s_waitcnt vmcnt(15) lgkmcnt(0)
s_barrier
ds_read_b128 v[32:35], v2 offset:16384
ds_read_b128 v[36:39], v3 offset:16384
ds_read_b128 v[40:43], v4 offset:16384
ds_read_b128 v[44:47], v5 offset:16384
ds_read_b64_tr_b16 v[240:241], v18 offset:16384
ds_read_b64_tr_b16 v[242:243], v19 offset:16384
ds_read_b64_tr_b16 v[96:97], v14 offset:0
ds_read_b64_tr_b16 v[98:99], v14 offset:512
ds_read_b64_tr_b16 v[100:101], v14 offset:4096
ds_read_b64_tr_b16 v[102:103], v14 offset:4608
ds_read_b64_tr_b16 v[104:105], v14 offset:8192
ds_read_b64_tr_b16 v[106:107], v14 offset:8704
ds_read_b64_tr_b16 v[108:109], v14 offset:12288
ds_read_b64_tr_b16 v[110:111], v14 offset:12800
s_waitcnt vmcnt(10) lgkmcnt(0)
s_barrier
ds_read_b128 v[48:51], v2 offset:36864
ds_read_b128 v[52:55], v3 offset:36864
ds_read_b128 v[56:59], v4 offset:36864
ds_read_b128 v[60:63], v5 offset:36864
s_add_u32 m0, s74, 0
v_mfma_f32_32x32x16_bf16 v[64:79], v[96:99], v[32:35], 0
ds_read_b64_tr_b16 v[244:245], v18 offset:36864
ds_read_b64_tr_b16 v[246:247], v19 offset:36864
ds_read_b64_tr_b16 v[112:113], v14 offset:20480
buffer_load_dwordx4 v29, s[4:7], s83 offen lds
s_add_u32 m0, s74, 4096
v_mfma_f32_32x32x16_bf16 v[64:79], v[100:103], v[36:39], v[64:79]
ds_read_b64_tr_b16 v[114:115], v14 offset:20992
ds_read_b64_tr_b16 v[116:117], v14 offset:24576
ds_read_b64_tr_b16 v[118:119], v14 offset:25088
buffer_load_dwordx4 v30, s[4:7], s81 offen lds
s_mul_i32 s73, s84, 1536
s_add_u32 m0, s74, 8192
v_mfma_f32_32x32x16_bf16 v[64:79], v[104:107], v[40:43], v[64:79]
ds_read_b64_tr_b16 v[120:121], v14 offset:28672
ds_read_b64_tr_b16 v[122:123], v14 offset:29184
buffer_load_dwordx4 v28, s[8:11], s73 offen lds
s_add_u32 s73, s73, 49152
s_add_u32 m0, s74, 12288
v_mfma_f32_32x32x16_bf16 v[64:79], v[108:111], v[44:47], v[64:79]
ds_read_b64_tr_b16 v[124:125], v14 offset:32768
ds_read_b64_tr_b16 v[126:127], v14 offset:33280
buffer_load_dwordx4 v28, s[8:11], s73 offen lds
s_add_u32 s73, s73, 49152
s_add_u32 m0, s74, 16384
s_nop 0
buffer_load_dwordx4 v28, s[8:11], s73 offen lds
s_waitcnt vmcnt(9) lgkmcnt(0)
s_barrier
ds_read_b128 v[32:35], v6 offset:16384
ds_read_b128 v[36:39], v6 offset:20480
ds_read_b128 v[40:43], v7 offset:16384
ds_read_b128 v[44:47], v7 offset:20480
s_add_u32 s73, s73, 49152
s_add_u32 m0, s74, 20480
v_mfma_f32_32x32x16_bf16 v[64:79], v[112:115], v[48:51], v[64:79]
ds_read_b128 v[48:51], v8 offset:16384
ds_read_b64_tr_b16 v[248:249], v18 offset:61440
ds_read_b64_tr_b16 v[250:251], v19 offset:61440
ds_read_b64_tr_b16 v[128:129], v15 offset:0
buffer_load_dwordx4 v28, s[8:11], s73 offen lds
s_add_u32 m0, s74, 24576
v_mfma_f32_32x32x16_bf16 v[64:79], v[116:119], v[52:55], v[64:79]
ds_read_b128 v[52:55], v8 offset:20480
ds_read_b64_tr_b16 v[130:131], v15 offset:512
ds_read_b64_tr_b16 v[132:133], v15 offset:4096
ds_read_b64_tr_b16 v[134:135], v15 offset:4608
buffer_load_dwordx4 v29, s[4:7], s84 offen lds
s_mul_i32 s73, s85, 1536
s_add_u32 m0, s74, 28672
v_mfma_f32_32x32x16_bf16 v[64:79], v[120:123], v[56:59], v[64:79]
ds_read_b128 v[56:59], v9 offset:16384
ds_read_b64_tr_b16 v[136:137], v15 offset:8192
ds_read_b64_tr_b16 v[138:139], v15 offset:8704
buffer_load_dwordx4 v28, s[8:11], s73 offen lds
s_add_u32 s73, s73, 49152
s_add_u32 m0, s74, 32768
v_mfma_f32_32x32x16_bf16 v[64:79], v[124:127], v[60:63], v[64:79]
ds_read_b128 v[60:63], v9 offset:20480
ds_read_b64_tr_b16 v[140:141], v15 offset:12288
ds_read_b64_tr_b16 v[142:143], v15 offset:12800
buffer_load_dwordx4 v28, s[8:11], s73 offen lds
s_add_u32 s73, s73, 49152
s_add_u32 m0, s74, 36864
s_nop 0
buffer_load_dwordx4 v28, s[8:11], s73 offen lds
s_waitcnt vmcnt(8) lgkmcnt(0)
s_barrier
s_add_u32 s73, s73, 49152
s_add_u32 m0, s74, 40960
v_mfma_f32_32x32x16_bf16 v[64:79], v[128:131], v[32:35], v[64:79]
ds_read_b128 v[32:35], v2 offset:0
ds_read_b64_tr_b16 v[252:253], v18 offset:4096
ds_read_b64_tr_b16 v[254:255], v19 offset:4096
buffer_load_dwordx4 v28, s[8:11], s73 offen lds
s_add_u32 m0, s74, 45056
v_mfma_f32_32x32x16_bf16 v[80:95], v[96:99], v[36:39], 0
ds_read_b128 v[36:39], v2 offset:4096
ds_read_b64_tr_b16 v[144:145], v15 offset:24576
ds_read_b64_tr_b16 v[146:147], v15 offset:25088
buffer_load_dwordx4 v29, s[4:7], s85 offen lds
s_mul_i32 s73, s86, 1536
s_add_u32 m0, s74, 49152
v_mfma_f32_32x32x16_bf16 v[64:79], v[132:135], v[40:43], v[64:79]
ds_read_b128 v[40:43], v3 offset:0
ds_read_b64_tr_b16 v[148:149], v15 offset:28672
buffer_load_dwordx4 v28, s[8:11], s73 offen lds
s_add_u32 s73, s73, 49152
s_add_u32 m0, s74, 53248
v_mfma_f32_32x32x16_bf16 v[80:95], v[100:103], v[44:47], v[80:95]
ds_read_b128 v[44:47], v3 offset:4096
ds_read_b64_tr_b16 v[150:151], v15 offset:29184
buffer_load_dwordx4 v28, s[8:11], s73 offen lds
s_add_u32 s73, s73, 49152
s_add_u32 m0, s74, 57344
v_mfma_f32_32x32x16_bf16 v[64:79], v[136:139], v[48:51], v[64:79]
ds_read_b128 v[48:51], v4 offset:0
ds_read_b64_tr_b16 v[152:153], v15 offset:32768
buffer_load_dwordx4 v28, s[8:11], s73 offen lds
s_add_u32 s73, s73, 49152
s_add_u32 m0, s74, 61440
v_mfma_f32_32x32x16_bf16 v[80:95], v[104:107], v[52:55], v[80:95]
ds_read_b128 v[52:55], v4 offset:4096
ds_read_b64_tr_b16 v[154:155], v15 offset:33280
buffer_load_dwordx4 v28, s[8:11], s73 offen lds
v_mfma_f32_32x32x16_bf16 v[64:79], v[140:143], v[56:59], v[64:79]
ds_read_b128 v[56:59], v5 offset:0
ds_read_b64_tr_b16 v[156:157], v15 offset:36864
v_mfma_f32_32x32x16_bf16 v[80:95], v[108:111], v[60:63], v[80:95]
ds_read_b128 v[60:63], v5 offset:4096
ds_read_b64_tr_b16 v[158:159], v15 offset:37376
s_waitcnt vmcnt(9) lgkmcnt(0)
s_barrier
s_add_u32 m0, s74, 65536
v_mfma_f32_32x32x16_bf16 v[64:79], v[144:147], v[32:35], v[64:79]
ds_read_b128 v[32:35], v2 offset:24576
ds_read_b64_tr_b16 v[160:161], v14 offset:8192
buffer_load_dwordx4 v29, s[4:7], s86 offen lds
s_add_u32 m0, s74, 69632
v_mfma_f32_32x32x16_bf16 v[80:95], v[112:115], v[36:39], v[80:95]
ds_read_b128 v[36:39], v3 offset:24576
ds_read_b64_tr_b16 v[162:163], v14 offset:8704
buffer_load_dwordx4 v30, s[4:7], s82 offen lds
s_mul_i32 s73, s87, 1536
s_add_u32 m0, s74, 73728
v_mfma_f32_32x32x16_bf16 v[64:79], v[148:151], v[40:43], v[64:79]
ds_read_b128 v[40:43], v4 offset:24576
ds_read_b64_tr_b16 v[164:165], v14 offset:12288
buffer_load_dwordx4 v28, s[8:11], s73 offen lds
s_add_u32 s73, s73, 49152
s_add_u32 m0, s74, 77824
v_mfma_f32_32x32x16_bf16 v[80:95], v[116:119], v[44:47], v[80:95]
ds_read_b128 v[44:47], v5 offset:24576
ds_read_b64_tr_b16 v[166:167], v14 offset:12800
buffer_load_dwordx4 v28, s[8:11], s73 offen lds
s_add_u32 s73, s73, 49152
s_add_u32 m0, s74, 0
v_mfma_f32_32x32x16_bf16 v[64:79], v[152:155], v[48:51], v[64:79]
ds_read_b64_tr_b16 v[168:169], v14 offset:16384
buffer_load_dwordx4 v28, s[8:11], s73 offen lds
s_add_u32 s73, s73, 49152
s_add_u32 m0, s74, 4096
v_mfma_f32_32x32x16_bf16 v[80:95], v[120:123], v[52:55], v[80:95]
ds_read_b64_tr_b16 v[170:171], v14 offset:16896
buffer_load_dwordx4 v28, s[8:11], s73 offen lds
v_mfma_f32_32x32x16_bf16 v[64:79], v[156:159], v[56:59], v[64:79]
ds_read_b64_tr_b16 v[172:173], v14 offset:20480
v_mfma_f32_32x32x16_bf16 v[80:95], v[124:127], v[60:63], v[80:95]
ds_read_b64_tr_b16 v[174:175], v14 offset:20992
buffer_store_dwordx4 v[240:243], v17, s[32:35], s23 offen sc1
buffer_store_dwordx4 v[244:247], v17, s[32:35], s30 offen sc1
buffer_store_dwordx4 v[248:251], v17, s[32:35], s31 offen sc1
buffer_store_dwordx4 v[252:255], v17, s[32:35], s77 offen sc1
s_waitcnt vmcnt(14) lgkmcnt(0)
s_barrier
ds_read_b128 v[48:51], v6 offset:4096
ds_read_b128 v[52:55], v7 offset:4096
ds_read_b128 v[56:59], v8 offset:4096
ds_read_b128 v[60:63], v9 offset:4096
s_add_u32 m0, s74, 8192
v_mfma_f32_32x32x16_bf16 v[64:79], v[160:163], v[32:35], v[64:79]
ds_read_b64_tr_b16 v[176:177], v14 offset:28672
ds_read_b64_tr_b16 v[178:179], v14 offset:29184
buffer_load_dwordx4 v29, s[4:7], s87 offen lds
s_add_u32 m0, s74, 12288
v_mfma_f32_32x32x16_bf16 v[64:79], v[164:167], v[36:39], v[64:79]
ds_read_b64_tr_b16 v[180:181], v14 offset:32768
ds_read_b64_tr_b16 v[182:183], v14 offset:33280
buffer_load_dwordx4 v30, s[4:7], s83 offen lds
s_mul_i32 s73, s88, 1536
s_add_u32 m0, s74, 16384
v_mfma_f32_32x32x16_bf16 v[64:79], v[168:171], v[40:43], v[64:79]
ds_read_b64_tr_b16 v[184:185], v14 offset:36864
ds_read_b64_tr_b16 v[186:187], v14 offset:37376
buffer_load_dwordx4 v28, s[8:11], s73 offen lds
s_add_u32 s73, s73, 49152
s_add_u32 m0, s74, 20480
v_mfma_f32_32x32x16_bf16 v[64:79], v[172:175], v[44:47], v[64:79]
ds_read_b64_tr_b16 v[188:189], v15 offset:0
ds_read_b64_tr_b16 v[190:191], v15 offset:512
buffer_load_dwordx4 v28, s[8:11], s73 offen lds
s_add_u32 s73, s73, 49152
s_add_u32 m0, s74, 24576
s_nop 0
buffer_load_dwordx4 v28, s[8:11], s73 offen lds
s_waitcnt vmcnt(13) lgkmcnt(0)
s_barrier
ds_read_b128 v[32:35], v6 offset:24576
ds_read_b128 v[36:39], v6 offset:28672
ds_read_b128 v[40:43], v7 offset:24576
ds_read_b128 v[44:47], v7 offset:28672
s_add_u32 s73, s73, 49152
s_add_u32 m0, s74, 28672
v_mfma_f32_32x32x16_bf16 v[64:79], v[176:179], v[48:51], v[64:79]
ds_read_b128 v[48:51], v8 offset:24576
ds_read_b64_tr_b16 v[192:193], v15 offset:8192
ds_read_b64_tr_b16 v[194:195], v15 offset:8704
buffer_load_dwordx4 v28, s[8:11], s73 offen lds
s_add_u32 m0, s74, 32768
v_mfma_f32_32x32x16_bf16 v[64:79], v[180:183], v[52:55], v[64:79]
ds_read_b128 v[52:55], v8 offset:28672
ds_read_b64_tr_b16 v[196:197], v15 offset:12288
ds_read_b64_tr_b16 v[198:199], v15 offset:12800
buffer_load_dwordx4 v29, s[4:7], s88 offen lds
s_add_u32 m0, s74, 36864
v_mfma_f32_32x32x16_bf16 v[64:79], v[184:187], v[56:59], v[64:79]
ds_read_b128 v[56:59], v9 offset:24576
ds_read_b64_tr_b16 v[200:201], v15 offset:16384
ds_read_b64_tr_b16 v[202:203], v15 offset:16896
buffer_load_dwordx4 v30, s[4:7], s84 offen lds
s_mul_i32 s73, s89, 1536
s_add_u32 m0, s74, 40960
v_mfma_f32_32x32x16_bf16 v[64:79], v[188:191], v[60:63], v[64:79]
ds_read_b128 v[60:63], v9 offset:28672
ds_read_b64_tr_b16 v[204:205], v15 offset:20480
ds_read_b64_tr_b16 v[206:207], v15 offset:20992
buffer_load_dwordx4 v28, s[8:11], s73 offen lds
s_add_u32 s73, s73, 49152
s_add_u32 m0, s74, 45056
s_nop 0
buffer_load_dwordx4 v28, s[8:11], s73 offen lds
s_waitcnt vmcnt(8) lgkmcnt(0)
s_barrier
s_mul_i32 s1, s1, 0x9e3779b1
s_add_u32 s1, s1, 0x7f4a7c15
s_or_b32 s1, s1, 1
s_cmp_lg_u32 s66, 0
s_cbranch_scc1 L_pub_1
v_mov_b32 v31, s1
s_mov_b64 exec, 1
buffer_store_dword v31, v1, s[24:27], s20 offen sc1
s_mov_b64 exec, -1
L_pub_1:
s_add_u32 s73, s73, 49152
s_add_u32 m0, s74, 49152
v_mfma_f32_32x32x16_bf16 v[64:79], v[192:195], v[32:35], v[64:79]
ds_read_b128 v[32:35], v2 offset:8192
ds_read_b64_tr_b16 v[208:209], v15 offset:32768
buffer_load_dwordx4 v28, s[8:11], s73 offen lds
s_add_u32 s73, s73, 49152
s_add_u32 m0, s74, 53248
v_mfma_f32_32x32x16_bf16 v[80:95], v[128:131], v[36:39], v[80:95]
ds_read_b128 v[36:39], v2 offset:12288
ds_read_b64_tr_b16 v[210:211], v15 offset:33280
buffer_load_dwordx4 v28, s[8:11], s73 offen lds
s_add_u32 m0, s74, 57344
v_mfma_f32_32x32x16_bf16 v[64:79], v[196:199], v[40:43], v[64:79]
ds_read_b128 v[40:43], v3 offset:8192
ds_read_b64_tr_b16 v[212:213], v15 offset:36864
buffer_load_dwordx4 v29, s[4:7], s89 offen lds
s_add_u32 m0, s74, 61440
v_mfma_f32_32x32x16_bf16 v[80:95], v[132:135], v[44:47], v[80:95]
ds_read_b128 v[44:47], v3 offset:12288
ds_read_b64_tr_b16 v[214:215], v15 offset:37376
buffer_load_dwordx4 v30, s[4:7], s85 offen lds
s_add_u32 m0, s74, 65536
v_mfma_f32_32x32x16_bf16 v[64:79], v[200:203], v[48:51], v[64:79]
ds_read_b128 v[48:51], v4 offset:8192
ds_read_b64_tr_b16 v[216:217], v14 offset:0
buffer_load_dwordx4 v30, s[4:7], s86 offen lds
s_add_u32 m0, s74, 69632
v_mfma_f32_32x32x16_bf16 v[80:95], v[136:139], v[52:55], v[80:95]
ds_read_b128 v[52:55], v4 offset:12288
ds_read_b64_tr_b16 v[218:219], v14 offset:512
buffer_load_dwordx4 v30, s[4:7], s87 offen lds
v_mfma_f32_32x32x16_bf16 v[64:79], v[204:207], v[56:59], v[64:79]
ds_read_b128 v[56:59], v5 offset:8192
ds_read_b64_tr_b16 v[220:221], v14 offset:4096
v_mfma_f32_32x32x16_bf16 v[80:95], v[140:143], v[60:63], v[80:95]
ds_read_b128 v[60:63], v5 offset:12288
ds_read_b64_tr_b16 v[222:223], v14 offset:4608
s_waitcnt vmcnt(8) lgkmcnt(0)
s_barrier
s_add_u32 m0, s74, 73728
v_mfma_f32_32x32x16_bf16 v[64:79], v[208:211], v[32:35], v[64:79]
ds_read_b128 v[32:35], v2 offset:32768
ds_read_b64_tr_b16 v[224:225], v14 offset:16384
buffer_load_dwordx4 v30, s[4:7], s88 offen lds
s_add_u32 m0, s74, 77824
v_mfma_f32_32x32x16_bf16 v[80:95], v[144:147], v[36:39], v[80:95]
ds_read_b128 v[36:39], v2 offset:36864
ds_read_b64_tr_b16 v[226:227], v14 offset:16896
buffer_load_dwordx4 v30, s[4:7], s89 offen lds
s_add_u32 m0, s74, 0
v_mfma_f32_32x32x16_bf16 v[64:79], v[212:215], v[40:43], v[64:79]
ds_read_b128 v[40:43], v3 offset:32768
ds_read_b64_tr_b16 v[228:229], v14 offset:20480
buffer_load_dwordx4 v10, s[4:7], s80 offen lds
s_add_u32 m0, s74, 4096
v_mfma_f32_32x32x16_bf16 v[80:95], v[148:151], v[44:47], v[80:95]
ds_read_b128 v[44:47], v3 offset:36864
ds_read_b64_tr_b16 v[230:231], v14 offset:20992
buffer_load_dwordx4 v10, s[4:7], s81 offen lds
s_add_u32 m0, s74, 8192
v_mfma_f32_32x32x16_bf16 v[64:79], v[216:219], v[48:51], v[64:79]
ds_read_b128 v[48:51], v4 offset:32768
ds_read_b64_tr_b16 v[232:233], v14 offset:24576
buffer_load_dwordx4 v10, s[4:7], s82 offen lds
s_add_u32 m0, s74, 12288
v_mfma_f32_32x32x16_bf16 v[80:95], v[152:155], v[52:55], v[80:95]
ds_read_b128 v[52:55], v4 offset:36864
ds_read_b64_tr_b16 v[234:235], v14 offset:25088
buffer_load_dwordx4 v10, s[4:7], s83 offen lds
v_mfma_f32_32x32x16_bf16 v[64:79], v[220:223], v[56:59], v[64:79]
ds_read_b128 v[56:59], v5 offset:32768
ds_read_b64_tr_b16 v[236:237], v14 offset:28672
v_mfma_f32_32x32x16_bf16 v[80:95], v[156:159], v[60:63], v[80:95]
ds_read_b128 v[60:63], v5 offset:36864
ds_read_b64_tr_b16 v[238:239], v14 offset:29184
s_waitcnt vmcnt(8) lgkmcnt(0)
s_barrier
s_add_u32 m0, s74, 16384
v_mfma_f32_32x32x16_bf16 v[64:79], v[224:227], v[32:35], v[64:79]
ds_read_b128 v[32:35], v6 offset:16384
ds_read_b64_tr_b16 v[240:241], v15 offset:0
buffer_load_dwordx4 v10, s[4:7], s84 offen lds
s_add_u32 m0, s74, 20480
v_mfma_f32_32x32x16_bf16 v[80:95], v[160:163], v[36:39], v[80:95]
ds_read_b128 v[36:39], v6 offset:20480
ds_read_b64_tr_b16 v[242:243], v15 offset:512
buffer_load_dwordx4 v10, s[4:7], s85 offen lds
s_add_u32 m0, s74, 24576
v_mfma_f32_32x32x16_bf16 v[64:79], v[228:231], v[40:43], v[64:79]
ds_read_b128 v[40:43], v7 offset:16384
ds_read_b64_tr_b16 v[244:245], v15 offset:4096
buffer_load_dwordx4 v10, s[4:7], s86 offen lds
s_add_u32 m0, s74, 28672
v_mfma_f32_32x32x16_bf16 v[80:95], v[164:167], v[44:47], v[80:95]
ds_read_b128 v[44:47], v7 offset:20480
ds_read_b64_tr_b16 v[246:247], v15 offset:4608
buffer_load_dwordx4 v10, s[4:7], s87 offen lds
s_add_u32 m0, s74, 32768
v_mfma_f32_32x32x16_bf16 v[64:79], v[232:235], v[48:51], v[64:79]
ds_read_b128 v[48:51], v8 offset:16384
ds_read_b64_tr_b16 v[248:249], v15 offset:8192
buffer_load_dwordx4 v10, s[4:7], s88 offen lds
s_add_u32 m0, s74, 36864
v_mfma_f32_32x32x16_bf16 v[80:95], v[168:171], v[52:55], v[80:95]
ds_read_b128 v[52:55], v8 offset:20480
ds_read_b64_tr_b16 v[250:251], v15 offset:8704
buffer_load_dwordx4 v10, s[4:7], s89 offen lds
s_add_u32 s21, s21, s90
s_cmp_eq_u32 s21, s22
s_cselect_b32 s21, 0, s21
s_sub_u32 s75, s75, 1
s_cmp_gt_i32 s75, 0
s_cselect_b32 s76, s21, 0x8000000
v_add_u32 v10, s76, v13
v_mfma_f32_32x32x16_bf16 v[64:79], v[236:239], v[56:59], v[64:79]
ds_read_b128 v[56:59], v9 offset:16384
ds_read_b64_tr_b16 v[252:253], v15 offset:12288
v_mfma_f32_32x32x16_bf16 v[80:95], v[172:175], v[60:63], v[80:95]
ds_read_b128 v[60:63], v9 offset:20480
ds_read_b64_tr_b16 v[254:255], v15 offset:12800
s_waitcnt vmcnt(10) lgkmcnt(0)
s_barrier
s_add_u32 m0, s74, 40960
v_mfma_f32_32x32x16_bf16 v[64:79], v[240:243], v[32:35], v[64:79]
ds_read_b128 v[32:35], v6 offset:24576
buffer_load_dwordx4 v10, s[4:7], s80 offen lds
s_add_u32 m0, s74, 45056
v_mfma_f32_32x32x16_bf16 v[80:95], v[176:179], v[36:39], v[80:95]
ds_read_b128 v[36:39], v7 offset:24576
buffer_load_dwordx4 v10, s[4:7], s81 offen lds
s_add_u32 m0, s74, 49152
v_mfma_f32_32x32x16_bf16 v[64:79], v[244:247], v[40:43], v[64:79]
ds_read_b128 v[40:43], v8 offset:24576
buffer_load_dwordx4 v10, s[4:7], s82 offen lds
s_add_u32 m0, s74, 53248
v_mfma_f32_32x32x16_bf16 v[80:95], v[180:183], v[44:47], v[80:95]
ds_read_b128 v[44:47], v9 offset:24576
buffer_load_dwordx4 v10, s[4:7], s83 offen lds
s_add_u32 m0, s74, 57344
v_mfma_f32_32x32x16_bf16 v[64:79], v[248:251], v[48:51], v[64:79]
ds_read_b128 v[48:51], v6 offset:28672
buffer_load_dwordx4 v10, s[4:7], s84 offen lds
s_add_u32 m0, s74, 61440
v_mfma_f32_32x32x16_bf16 v[80:95], v[184:187], v[52:55], v[80:95]
ds_read_b128 v[52:55], v7 offset:28672
buffer_load_dwordx4 v10, s[4:7], s85 offen lds
v_mfma_f32_32x32x16_bf16 v[64:79], v[252:255], v[56:59], v[64:79]
ds_read_b128 v[56:59], v8 offset:28672
v_mfma_f32_32x32x16_bf16 v[80:95], v[188:191], v[60:63], v[80:95]
ds_read_b128 v[60:63], v9 offset:28672
s_waitcnt lgkmcnt(7)
v_mfma_f32_32x32x16_bf16 v[80:95], v[192:195], v[32:35], v[80:95]
ds_read_b128 v[32:35], v6 offset:32768
s_waitcnt lgkmcnt(7)
v_mfma_f32_32x32x16_bf16 v[80:95], v[196:199], v[36:39], v[80:95]
ds_read_b128 v[36:39], v7 offset:32768
s_nop 2
v_mul_f32 v16, v64, v64
v_mul_f32 v17, v65, v65
v_mul_f32 v18, v66, v66
v_mul_f32 v19, v67, v67
v_mul_f32 v72, v64, v72
v_mul_f32 v73, v65, v73
v_mul_f32 v74, v66, v74
s_waitcnt lgkmcnt(7)
v_mfma_f32_32x32x16_bf16 v[80:95], v[200:203], v[40:43], v[80:95]
ds_read_b128 v[40:43], v8 offset:32768
v_mul_f32 v75, v67, v75
v_fmaak_f32 v16, v12, v16, 0xc0135761
v_fmaak_f32 v17, v12, v17, 0xc0135761
v_fmaak_f32 v18, v12, v18, 0xc0135761
v_fmaak_f32 v19, v12, v19, 0xc0135761
v_mul_f32 v16, v16, v64
s_waitcnt lgkmcnt(7)
v_mfma_f32_32x32x16_bf16 v[80:95], v[204:207], v[44:47], v[80:95]
ds_read_b128 v[44:47], v9 offset:32768
v_mul_f32 v17, v17, v65
v_mul_f32 v18, v18, v66
v_mul_f32 v19, v19, v67
v_exp_f32 v16, v16
v_exp_f32 v17, v17
s_waitcnt lgkmcnt(7)
v_mfma_f32_32x32x16_bf16 v[80:95], v[208:211], v[48:51], v[80:95]
ds_read_b128 v[48:51], v6 offset:36864
v_exp_f32 v18, v18
v_exp_f32 v19, v19
v_add_f32 v16, 1.0, v16
s_waitcnt lgkmcnt(7)
v_mfma_f32_32x32x16_bf16 v[80:95], v[212:215], v[52:55], v[80:95]
ds_read_b128 v[52:55], v7 offset:36864
v_add_f32 v17, 1.0, v17
v_add_f32 v18, 1.0, v18
v_add_f32 v19, 1.0, v19
v_rcp_f32 v16, v16
v_rcp_f32 v17, v17
s_waitcnt lgkmcnt(7)
v_mfma_f32_32x32x16_bf16 v[80:95], v[216:219], v[56:59], v[80:95]
ds_read_b128 v[56:59], v8 offset:36864
v_rcp_f32 v18, v18
v_rcp_f32 v19, v19
v_mul_f32 v72, v72, v16
s_waitcnt lgkmcnt(7)
v_mfma_f32_32x32x16_bf16 v[80:95], v[220:223], v[60:63], v[80:95]
ds_read_b128 v[60:63], v9 offset:36864
v_mul_f32 v73, v73, v17
v_mul_f32 v74, v74, v18
v_mul_f32 v75, v75, v19
v_cvt_pk_bf16_f32 v24, v72, v73
v_cvt_pk_bf16_f32 v25, v74, v75
v_mul_f32 v16, v68, v68
s_waitcnt lgkmcnt(7)
v_mfma_f32_32x32x16_bf16 v[80:95], v[224:227], v[32:35], v[80:95]
v_mul_f32 v17, v69, v69
v_mul_f32 v18, v70, v70
v_mul_f32 v19, v71, v71
v_mul_f32 v76, v68, v76
v_mul_f32 v77, v69, v77
v_mul_f32 v78, v70, v78
s_waitcnt lgkmcnt(6)
v_mfma_f32_32x32x16_bf16 v[80:95], v[228:231], v[36:39], v[80:95]
v_mul_f32 v79, v71, v79
v_fmaak_f32 v16, v12, v16, 0xc0135761
v_fmaak_f32 v17, v12, v17, 0xc0135761
v_fmaak_f32 v18, v12, v18, 0xc0135761
v_fmaak_f32 v19, v12, v19, 0xc0135761
v_mul_f32 v16, v16, v68
s_waitcnt lgkmcnt(5)
v_mfma_f32_32x32x16_bf16 v[80:95], v[232:235], v[40:43], v[80:95]
v_mul_f32 v17, v17, v69
v_mul_f32 v18, v18, v70
v_mul_f32 v19, v19, v71
v_exp_f32 v16, v16
v_exp_f32 v17, v17
s_waitcnt lgkmcnt(4)
v_mfma_f32_32x32x16_bf16 v[80:95], v[236:239], v[44:47], v[80:95]
v_exp_f32 v18, v18
v_exp_f32 v19, v19
v_add_f32 v16, 1.0, v16
s_waitcnt lgkmcnt(3)
v_mfma_f32_32x32x16_bf16 v[80:95], v[240:243], v[48:51], v[80:95]
s_waitcnt vmcnt(11) lgkmcnt(0)
s_barrier
ds_read_b128 v[32:35], v2 offset:0
ds_read_b128 v[36:39], v3 offset:0
ds_read_b128 v[40:43], v4 offset:0
v_add_f32 v17, 1.0, v17
v_add_f32 v18, 1.0, v18
v_add_f32 v19, 1.0, v19
v_rcp_f32 v16, v16
v_rcp_f32 v17, v17
s_waitcnt lgkmcnt(5)
v_mfma_f32_32x32x16_bf16 v[80:95], v[244:247], v[52:55], v[80:95]
ds_read_b128 v[44:47], v5 offset:0
v_rcp_f32 v18, v18
v_rcp_f32 v19, v19
v_mul_f32 v76, v76, v16
s_waitcnt lgkmcnt(5)
v_mfma_f32_32x32x16_bf16 v[80:95], v[248:251], v[56:59], v[80:95]
ds_read_b128 v[48:51], v2 offset:4096
v_mul_f32 v77, v77, v17
v_mul_f32 v78, v78, v18
v_mul_f32 v79, v79, v19
v_cvt_pk_bf16_f32 v26, v76, v77
v_cvt_pk_bf16_f32 v27, v78, v79
buffer_store_dwordx4 v[24:27], v11, s[16:19], s78 offen sc1
s_waitcnt lgkmcnt(5)
v_mfma_f32_32x32x16_bf16 v[80:95], v[252:255], v[60:63], v[80:95]
ds_read_b128 v[52:55], v3 offset:4096
s_add_u32 s78, s78, 98304
s_cmp_eq_u32 s78, s29
s_cselect_b32 s78, s28, s78
s_mul_i32 s70, s66, 3072
s_add_u32 s70, s70, 8192
v_min_u32 v29, 23, v0
v_lshl_add_u32 v29, v29, 7, s70
buffer_load_dword v30, v29, s[24:27], 0 offen sc1
s_mov_b32 s50, 0
s_mov_b32 s51, 0
s_lshr_b32 s70, s67, 3
s_and_b32 s71, s67, 7
s_mul_i32 s12, s71, 245760
s_mul_i32 s73, s66, 12288
s_add_u32 s12, s12, s73
s_mul_i32 s70, s70, 3
s_mul_i32 s71, s71, 3
s_lshr_b32 s71, s71, 1
s_add_u32 s70, s70, s71
s_sub_u32 s73, s70, 12
s_cselect_b32 s70, s70, s73
s_add_u32 s70, s70, 6
s_and_b32 s71, s79, 1
s_lshl_b32 s71, s71, 1
s_add_u32 s13, s70, s71
s_xor_b32 s71, s71, 2
s_add_u32 s20, s70, s71
s_sub_u32 s73, s13, 12
s_cselect_b32 s13, s13, s73
s_sub_u32 s73, s13, 12
s_cselect_b32 s13, s13, s73
s_sub_u32 s73, s20, 12
s_cselect_b32 s20, s20, s73
s_sub_u32 s73, s20, 12
s_cselect_b32 s20, s20, s73
s_cmp_lt_u32 s67, 12
s_cselect_b64 s[14:15], -1, 0
s_add_u32 s8, s64, 12582912
s_addc_u32 s9, s65, 0
s_mov_b32 s10, 1966080
s_mov_b32 s11, 0x20000
s_sub_u32 s79, s79, 2
s_cmp_eq_u32 s79, 0
s_cbranch_scc1 L_g1tail_3
L_g1top_4:
s_add_u32 m0, s74, 65536
s_waitcnt lgkmcnt(5)
v_mfma_f32_32x32x16_bf16 v[64:79], v[96:99], v[32:35], 0
ds_read_b128 v[56:59], v4 offset:4096
buffer_load_dwordx4 v10, s[4:7], s86 offen sc1 lds
s_waitcnt lgkmcnt(5)
v_mfma_f32_32x32x16_bf16 v[64:79], v[100:103], v[36:39], v[64:79]
ds_read_b128 v[60:63], v5 offset:4096
v_mul_f32 v16, v80, v80
v_mul_f32 v17, v81, v81
v_mul_f32 v18, v82, v82
s_waitcnt lgkmcnt(5)
v_mfma_f32_32x32x16_bf16 v[64:79], v[104:107], v[40:43], v[64:79]
ds_read_b128 v[32:35], v2 offset:8192
v_mul_f32 v19, v83, v83
v_mul_f32 v88, v80, v88
s_waitcnt lgkmcnt(5)
v_mfma_f32_32x32x16_bf16 v[64:79], v[108:111], v[44:47], v[64:79]
ds_read_b128 v[36:39], v3 offset:8192
v_mul_f32 v89, v81, v89
v_mul_f32 v90, v82, v90
s_add_u32 m0, s74, 69632
s_waitcnt lgkmcnt(5)
v_mfma_f32_32x32x16_bf16 v[64:79], v[112:115], v[48:51], v[64:79]
ds_read_b128 v[40:43], v4 offset:8192
buffer_load_dwordx4 v10, s[4:7], s87 offen sc1 lds
v_mul_f32 v91, v83, v91
v_fmaak_f32 v16, v12, v16, 0xc0135761
s_waitcnt lgkmcnt(5)
v_mfma_f32_32x32x16_bf16 v[64:79], v[116:119], v[52:55], v[64:79]
ds_read_b128 v[44:47], v5 offset:8192
v_fmaak_f32 v17, v12, v17, 0xc0135761
v_fmaak_f32 v18, v12, v18, 0xc0135761
v_fmaak_f32 v19, v12, v19, 0xc0135761
s_waitcnt lgkmcnt(5)
v_mfma_f32_32x32x16_bf16 v[64:79], v[120:123], v[56:59], v[64:79]
ds_read_b128 v[48:51], v2 offset:12288
v_mul_f32 v16, v16, v80
v_mul_f32 v17, v17, v81
s_waitcnt lgkmcnt(5)
v_mfma_f32_32x32x16_bf16 v[64:79], v[124:127], v[60:63], v[64:79]
ds_read_b128 v[52:55], v3 offset:12288
v_mul_f32 v18, v18, v82
v_mul_f32 v19, v19, v83
s_add_u32 m0, s74, 73728
s_waitcnt lgkmcnt(5)
v_mfma_f32_32x32x16_bf16 v[64:79], v[128:131], v[32:35], v[64:79]
ds_read_b128 v[56:59], v4 offset:12288
buffer_load_dwordx4 v10, s[4:7], s88 offen sc1 lds
v_exp_f32 v16, v16
s_waitcnt lgkmcnt(5)
v_mfma_f32_32x32x16_bf16 v[64:79], v[132:135], v[36:39], v[64:79]
ds_read_b128 v[60:63], v5 offset:12288
v_exp_f32 v17, v17
v_exp_f32 v18, v18
s_waitcnt lgkmcnt(5)
v_mfma_f32_32x32x16_bf16 v[64:79], v[136:139], v[40:43], v[64:79]
ds_read_b128 v[32:35], v2 offset:16384
v_exp_f32 v19, v19
s_waitcnt lgkmcnt(5)
v_mfma_f32_32x32x16_bf16 v[64:79], v[140:143], v[44:47], v[64:79]
ds_read_b128 v[36:39], v3 offset:16384
v_add_f32 v16, 1.0, v16
s_add_u32 m0, s74, 77824
s_waitcnt lgkmcnt(5)
v_mfma_f32_32x32x16_bf16 v[64:79], v[144:147], v[48:51], v[64:79]
ds_read_b128 v[40:43], v4 offset:16384
buffer_load_dwordx4 v10, s[4:7], s89 offen sc1 lds
s_add_u32 s21, s21, s90
s_cmp_eq_u32 s21, s22
s_cselect_b32 s21, 0, s21
s_sub_u32 s75, s75, 1
s_cmp_gt_i32 s75, 0
s_cselect_b32 s76, s21, 0x8000000
v_add_u32 v10, s76, v13
s_cbranch_scc1 L_sw_5
s_waitcnt vmcnt(10)
v_cmp_ne_u32 vcc, s1, v30
s_nop 0
s_or_b64 vcc, vcc, s[14:15]
s_cmp_lg_u64 vcc, 0
s_cbranch_scc1 L_sw_5
s_mov_b64 s[4:5], s[8:9]
s_mov_b32 s6, s10
s_mov_b32 s51, s50
s_mov_b32 s50, 1
v_lshlrev_b32 v10, 4, v0
s_lshl_b32 s73, s13, 10
s_add_u32 s80, s12, s73
s_add_u32 s81, s80, 49152
s_add_u32 s82, s81, 49152
s_add_u32 s83, s82, 49152
s_add_u32 s84, s83, 49152
s_add_u32 s13, s13, 1
s_cmp_ge_u32 s13, 12
s_cselect_b32 s13, 0, s13
s_lshl_b32 s73, s13, 10
s_add_u32 s85, s12, s73
s_add_u32 s86, s85, 49152
s_add_u32 s87, s86, 49152
s_add_u32 s88, s87, 49152
s_add_u32 s89, s88, 49152
s_mov_b32 s13, s20
L_sw_5:
v_add_f32 v17, 1.0, v17
v_add_f32 v18, 1.0, v18
s_waitcnt lgkmcnt(5)
v_mfma_f32_32x32x16_bf16 v[64:79], v[148:151], v[52:55], v[64:79]
ds_read_b128 v[44:47], v5 offset:16384
v_add_f32 v19, 1.0, v19
v_rcp_f32 v16, v16
s_waitcnt lgkmcnt(5)
v_mfma_f32_32x32x16_bf16 v[64:79], v[152:155], v[56:59], v[64:79]
v_rcp_f32 v17, v17
s_waitcnt lgkmcnt(4)
v_mfma_f32_32x32x16_bf16 v[64:79], v[156:159], v[60:63], v[64:79]
v_rcp_f32 v18, v18
s_add_u32 m0, s74, 0
s_waitcnt lgkmcnt(3)
v_mfma_f32_32x32x16_bf16 v[64:79], v[160:163], v[32:35], v[64:79]
s_waitcnt vmcnt(10) lgkmcnt(0)
s_barrier
ds_read_b128 v[48:51], v2 offset:20480
ds_read_b128 v[52:55], v3 offset:20480
ds_read_b128 v[56:59], v4 offset:20480
buffer_load_dwordx4 v10, s[4:7], s80 offen sc1 lds
v_rcp_f32 v19, v19
s_waitcnt lgkmcnt(5)
v_mfma_f32_32x32x16_bf16 v[64:79], v[164:167], v[36:39], v[64:79]
ds_read_b128 v[60:63], v5 offset:20480
v_mul_f32 v88, v88, v16
v_mul_f32 v89, v89, v17
v_mul_f32 v90, v90, v18
s_waitcnt lgkmcnt(5)
v_mfma_f32_32x32x16_bf16 v[64:79], v[168:171], v[40:43], v[64:79]
ds_read_b128 v[32:35], v2 offset:24576
v_mul_f32 v91, v91, v19
v_cvt_pk_bf16_f32 v24, v88, v89
s_waitcnt lgkmcnt(5)
v_mfma_f32_32x32x16_bf16 v[64:79], v[172:175], v[44:47], v[64:79]
ds_read_b128 v[36:39], v3 offset:24576
v_cvt_pk_bf16_f32 v25, v90, v91
v_mul_f32 v16, v84, v84
s_add_u32 m0, s74, 4096
s_waitcnt lgkmcnt(5)
v_mfma_f32_32x32x16_bf16 v[64:79], v[176:179], v[48:51], v[64:79]
ds_read_b128 v[40:43], v4 offset:24576
buffer_load_dwordx4 v10, s[4:7], s81 offen sc1 lds
v_mul_f32 v17, v85, v85
v_mul_f32 v18, v86, v86
s_waitcnt lgkmcnt(5)
v_mfma_f32_32x32x16_bf16 v[64:79], v[180:183], v[52:55], v[64:79]
ds_read_b128 v[44:47], v5 offset:24576
v_mul_f32 v19, v87, v87
v_mul_f32 v92, v84, v92
s_waitcnt lgkmcnt(5)
v_mfma_f32_32x32x16_bf16 v[64:79], v[184:187], v[56:59], v[64:79]
ds_read_b128 v[48:51], v2 offset:28672
v_mul_f32 v93, v85, v93
v_mul_f32 v94, v86, v94
v_mul_f32 v95, v87, v95
s_waitcnt lgkmcnt(5)
v_mfma_f32_32x32x16_bf16 v[64:79], v[188:191], v[60:63], v[64:79]
ds_read_b128 v[52:55], v3 offset:28672
v_fmaak_f32 v16, v12, v16, 0xc0135761
v_fmaak_f32 v17, v12, v17, 0xc0135761
s_add_u32 m0, s74, 8192
s_waitcnt lgkmcnt(5)
v_mfma_f32_32x32x16_bf16 v[64:79], v[192:195], v[32:35], v[64:79]
ds_read_b128 v[56:59], v4 offset:28672
buffer_load_dwordx4 v10, s[4:7], s82 offen sc1 lds
v_fmaak_f32 v18, v12, v18, 0xc0135761
v_fmaak_f32 v19, v12, v19, 0xc0135761
s_waitcnt lgkmcnt(5)
v_mfma_f32_32x32x16_bf16 v[64:79], v[196:199], v[36:39], v[64:79]
ds_read_b128 v[60:63], v5 offset:28672
v_mul_f32 v16, v16, v84
v_mul_f32 v17, v17, v85
s_waitcnt lgkmcnt(5)
v_mfma_f32_32x32x16_bf16 v[64:79], v[200:203], v[40:43], v[64:79]
ds_read_b128 v[32:35], v2 offset:32768
v_mul_f32 v18, v18, v86
v_mul_f32 v19, v19, v87
v_exp_f32 v16, v16
s_waitcnt lgkmcnt(5)
v_mfma_f32_32x32x16_bf16 v[64:79], v[204:207], v[44:47], v[64:79]
ds_read_b128 v[36:39], v3 offset:32768
v_exp_f32 v17, v17
s_add_u32 m0, s74, 12288
s_waitcnt lgkmcnt(5)
v_mfma_f32_32x32x16_bf16 v[64:79], v[208:211], v[48:51], v[64:79]
ds_read_b128 v[40:43], v4 offset:32768
buffer_load_dwordx4 v10, s[4:7], s83 offen sc1 lds
v_exp_f32 v18, v18
s_waitcnt lgkmcnt(5)
v_mfma_f32_32x32x16_bf16 v[64:79], v[212:215], v[52:55], v[64:79]
ds_read_b128 v[44:47], v5 offset:32768
v_exp_f32 v19, v19
s_waitcnt lgkmcnt(5)
v_mfma_f32_32x32x16_bf16 v[64:79], v[216:219], v[56:59], v[64:79]
ds_read_b128 v[48:51], v2 offset:36864
v_add_f32 v16, 1.0, v16
v_add_f32 v17, 1.0, v17
s_waitcnt lgkmcnt(5)
v_mfma_f32_32x32x16_bf16 v[64:79], v[220:223], v[60:63], v[64:79]
ds_read_b128 v[52:55], v3 offset:36864
v_add_f32 v18, 1.0, v18
v_add_f32 v19, 1.0, v19
s_add_u32 m0, s74, 16384
s_waitcnt lgkmcnt(5)
v_mfma_f32_32x32x16_bf16 v[64:79], v[224:227], v[32:35], v[64:79]
ds_read_b128 v[56:59], v4 offset:36864
buffer_load_dwordx4 v10, s[4:7], s84 offen sc1 lds
v_rcp_f32 v16, v16
s_waitcnt lgkmcnt(5)
v_mfma_f32_32x32x16_bf16 v[64:79], v[228:231], v[36:39], v[64:79]
ds_read_b128 v[60:63], v5 offset:36864
v_rcp_f32 v17, v17
s_waitcnt lgkmcnt(5)
v_mfma_f32_32x32x16_bf16 v[64:79], v[232:235], v[40:43], v[64:79]
v_rcp_f32 v18, v18
v_rcp_f32 v19, v19
s_waitcnt lgkmcnt(4)
v_mfma_f32_32x32x16_bf16 v[64:79], v[236:239], v[44:47], v[64:79]
v_mul_f32 v92, v92, v16
s_add_u32 m0, s74, 20480
s_waitcnt lgkmcnt(3)
v_mfma_f32_32x32x16_bf16 v[64:79], v[240:243], v[48:51], v[64:79]
s_waitcnt vmcnt(10) lgkmcnt(0)
s_barrier
ds_read_b128 v[32:35], v6 offset:0
ds_read_b128 v[36:39], v7 offset:0
ds_read_b128 v[40:43], v8 offset:0
buffer_load_dwordx4 v10, s[4:7], s85 offen sc1 lds
v_mul_f32 v93, v93, v17
v_mul_f32 v94, v94, v18
s_waitcnt lgkmcnt(5)
v_mfma_f32_32x32x16_bf16 v[64:79], v[244:247], v[52:55], v[64:79]
ds_read_b128 v[44:47], v9 offset:0
v_mul_f32 v95, v95, v19
v_cvt_pk_bf16_f32 v26, v92, v93
s_waitcnt lgkmcnt(5)
v_mfma_f32_32x32x16_bf16 v[64:79], v[248:251], v[56:59], v[64:79]
ds_read_b128 v[48:51], v6 offset:4096
v_cvt_pk_bf16_f32 v27, v94, v95
buffer_store_dwordx4 v[24:27], v11, s[16:19], s78 offen sc1
s_waitcnt lgkmcnt(5)
v_mfma_f32_32x32x16_bf16 v[64:79], v[252:255], v[60:63], v[64:79]
ds_read_b128 v[52:55], v7 offset:4096
s_add_u32 s78, s78, 98304
s_cmp_eq_u32 s78, s29
s_cselect_b32 s78, s28, s78
s_sub_u32 s79, s79, 1
s_cmp_eq_u32 s79, 0
s_cbranch_scc1 L_g1tail_2
s_add_u32 m0, s74, 24576
s_waitcnt lgkmcnt(5)
v_mfma_f32_32x32x16_bf16 v[80:95], v[96:99], v[32:35], 0
ds_read_b128 v[56:59], v8 offset:4096
buffer_load_dwordx4 v10, s[4:7], s86 offen sc1 lds
s_waitcnt lgkmcnt(5)
v_mfma_f32_32x32x16_bf16 v[80:95], v[100:103], v[36:39], v[80:95]
ds_read_b128 v[60:63], v9 offset:4096
v_mul_f32 v16, v64, v64
v_mul_f32 v17, v65, v65
v_mul_f32 v18, v66, v66
s_waitcnt lgkmcnt(5)
v_mfma_f32_32x32x16_bf16 v[80:95], v[104:107], v[40:43], v[80:95]
ds_read_b128 v[32:35], v6 offset:8192
v_mul_f32 v19, v67, v67
v_mul_f32 v72, v64, v72
s_waitcnt lgkmcnt(5)
v_mfma_f32_32x32x16_bf16 v[80:95], v[108:111], v[44:47], v[80:95]
ds_read_b128 v[36:39], v7 offset:8192
v_mul_f32 v73, v65, v73
v_mul_f32 v74, v66, v74
s_add_u32 m0, s74, 28672
s_waitcnt lgkmcnt(5)
v_mfma_f32_32x32x16_bf16 v[80:95], v[112:115], v[48:51], v[80:95]
ds_read_b128 v[40:43], v8 offset:8192
buffer_load_dwordx4 v10, s[4:7], s87 offen sc1 lds
v_mul_f32 v75, v67, v75
v_fmaak_f32 v16, v12, v16, 0xc0135761
s_waitcnt lgkmcnt(5)
v_mfma_f32_32x32x16_bf16 v[80:95], v[116:119], v[52:55], v[80:95]
ds_read_b128 v[44:47], v9 offset:8192
v_fmaak_f32 v17, v12, v17, 0xc0135761
v_fmaak_f32 v18, v12, v18, 0xc0135761
v_fmaak_f32 v19, v12, v19, 0xc0135761
s_waitcnt lgkmcnt(5)
v_mfma_f32_32x32x16_bf16 v[80:95], v[120:123], v[56:59], v[80:95]
ds_read_b128 v[48:51], v6 offset:12288
v_mul_f32 v16, v16, v64
v_mul_f32 v17, v17, v65
s_waitcnt lgkmcnt(5)
v_mfma_f32_32x32x16_bf16 v[80:95], v[124:127], v[60:63], v[80:95]
ds_read_b128 v[52:55], v7 offset:12288
v_mul_f32 v18, v18, v66
v_mul_f32 v19, v19, v67
s_add_u32 m0, s74, 32768
s_waitcnt lgkmcnt(5)
v_mfma_f32_32x32x16_bf16 v[80:95], v[128:131], v[32:35], v[80:95]
ds_read_b128 v[56:59], v8 offset:12288
buffer_load_dwordx4 v10, s[4:7], s88 offen sc1 lds
v_exp_f32 v16, v16
s_waitcnt lgkmcnt(5)
v_mfma_f32_32x32x16_bf16 v[80:95], v[132:135], v[36:39], v[80:95]
ds_read_b128 v[60:63], v9 offset:12288
v_exp_f32 v17, v17
v_exp_f32 v18, v18
s_waitcnt lgkmcnt(5)
v_mfma_f32_32x32x16_bf16 v[80:95], v[136:139], v[40:43], v[80:95]
ds_read_b128 v[32:35], v6 offset:16384
v_exp_f32 v19, v19
s_waitcnt lgkmcnt(5)
v_mfma_f32_32x32x16_bf16 v[80:95], v[140:143], v[44:47], v[80:95]
ds_read_b128 v[36:39], v7 offset:16384
v_add_f32 v16, 1.0, v16
s_add_u32 m0, s74, 36864
s_waitcnt lgkmcnt(5)
v_mfma_f32_32x32x16_bf16 v[80:95], v[144:147], v[48:51], v[80:95]
ds_read_b128 v[40:43], v8 offset:16384
buffer_load_dwordx4 v10, s[4:7], s89 offen sc1 lds
s_add_u32 s21, s21, s90
s_cmp_eq_u32 s21, s22
s_cselect_b32 s21, 0, s21
s_sub_u32 s75, s75, 1
s_cmp_gt_i32 s75, 0
s_cselect_b32 s76, s21, 0x8000000
v_add_u32 v10, s76, v13
s_cbranch_scc1 L_sw_6
s_waitcnt vmcnt(10)
v_cmp_ne_u32 vcc, s1, v30
s_nop 0
s_or_b64 vcc, vcc, s[14:15]
s_cmp_lg_u64 vcc, 0
s_cbranch_scc1 L_sw_6
s_mov_b64 s[4:5], s[8:9]
s_mov_b32 s6, s10
s_mov_b32 s51, s50
s_mov_b32 s50, 1
v_lshlrev_b32 v10, 4, v0
s_lshl_b32 s73, s13, 10
s_add_u32 s80, s12, s73
s_add_u32 s81, s80, 49152
s_add_u32 s82, s81, 49152
s_add_u32 s83, s82, 49152
s_add_u32 s84, s83, 49152
s_add_u32 s13, s13, 1
s_cmp_ge_u32 s13, 12
s_cselect_b32 s13, 0, s13
s_lshl_b32 s73, s13, 10
s_add_u32 s85, s12, s73
s_add_u32 s86, s85, 49152
s_add_u32 s87, s86, 49152
s_add_u32 s88, s87, 49152
s_add_u32 s89, s88, 49152
s_mov_b32 s13, s20
L_sw_6:
v_add_f32 v17, 1.0, v17
v_add_f32 v18, 1.0, v18
s_waitcnt lgkmcnt(5)
v_mfma_f32_32x32x16_bf16 v[80:95], v[148:151], v[52:55], v[80:95]
ds_read_b128 v[44:47], v9 offset:16384
v_add_f32 v19, 1.0, v19
v_rcp_f32 v16, v16
s_waitcnt lgkmcnt(5)
v_mfma_f32_32x32x16_bf16 v[80:95], v[152:155], v[56:59], v[80:95]
v_rcp_f32 v17, v17
s_waitcnt lgkmcnt(4)
v_mfma_f32_32x32x16_bf16 v[80:95], v[156:159], v[60:63], v[80:95]
v_rcp_f32 v18, v18
s_add_u32 m0, s74, 40960
s_waitcnt lgkmcnt(3)
v_mfma_f32_32x32x16_bf16 v[80:95], v[160:163], v[32:35], v[80:95]
s_waitcnt vmcnt(10) lgkmcnt(0)
s_barrier
ds_read_b128 v[48:51], v6 offset:20480
ds_read_b128 v[52:55], v7 offset:20480
ds_read_b128 v[56:59], v8 offset:20480
buffer_load_dwordx4 v10, s[4:7], s80 offen sc1 lds
v_rcp_f32 v19, v19
s_waitcnt lgkmcnt(5)
v_mfma_f32_32x32x16_bf16 v[80:95], v[164:167], v[36:39], v[80:95]
ds_read_b128 v[60:63], v9 offset:20480
v_mul_f32 v72, v72, v16
v_mul_f32 v73, v73, v17
v_mul_f32 v74, v74, v18
s_waitcnt lgkmcnt(5)
v_mfma_f32_32x32x16_bf16 v[80:95], v[168:171], v[40:43], v[80:95]
ds_read_b128 v[32:35], v6 offset:24576
v_mul_f32 v75, v75, v19
v_cvt_pk_bf16_f32 v24, v72, v73
s_waitcnt lgkmcnt(5)
v_mfma_f32_32x32x16_bf16 v[80:95], v[172:175], v[44:47], v[80:95]
ds_read_b128 v[36:39], v7 offset:24576
v_cvt_pk_bf16_f32 v25, v74, v75
v_mul_f32 v16, v68, v68
s_add_u32 m0, s74, 45056
s_waitcnt lgkmcnt(5)
v_mfma_f32_32x32x16_bf16 v[80:95], v[176:179], v[48:51], v[80:95]
ds_read_b128 v[40:43], v8 offset:24576
buffer_load_dwordx4 v10, s[4:7], s81 offen sc1 lds
v_mul_f32 v17, v69, v69
v_mul_f32 v18, v70, v70
s_waitcnt lgkmcnt(5)
v_mfma_f32_32x32x16_bf16 v[80:95], v[180:183], v[52:55], v[80:95]
ds_read_b128 v[44:47], v9 offset:24576
v_mul_f32 v19, v71, v71
v_mul_f32 v76, v68, v76
s_waitcnt lgkmcnt(5)
v_mfma_f32_32x32x16_bf16 v[80:95], v[184:187], v[56:59], v[80:95]
ds_read_b128 v[48:51], v6 offset:28672
v_mul_f32 v77, v69, v77
v_mul_f32 v78, v70, v78
v_mul_f32 v79, v71, v79
s_waitcnt lgkmcnt(5)
v_mfma_f32_32x32x16_bf16 v[80:95], v[188:191], v[60:63], v[80:95]
ds_read_b128 v[52:55], v7 offset:28672
v_fmaak_f32 v16, v12, v16, 0xc0135761
v_fmaak_f32 v17, v12, v17, 0xc0135761
s_add_u32 m0, s74, 49152
s_waitcnt lgkmcnt(5)
v_mfma_f32_32x32x16_bf16 v[80:95], v[192:195], v[32:35], v[80:95]
ds_read_b128 v[56:59], v8 offset:28672
buffer_load_dwordx4 v10, s[4:7], s82 offen sc1 lds
v_fmaak_f32 v18, v12, v18, 0xc0135761
v_fmaak_f32 v19, v12, v19, 0xc0135761
s_waitcnt lgkmcnt(5)
v_mfma_f32_32x32x16_bf16 v[80:95], v[196:199], v[36:39], v[80:95]
ds_read_b128 v[60:63], v9 offset:28672
v_mul_f32 v16, v16, v68
v_mul_f32 v17, v17, v69
s_waitcnt lgkmcnt(5)
v_mfma_f32_32x32x16_bf16 v[80:95], v[200:203], v[40:43], v[80:95]
ds_read_b128 v[32:35], v6 offset:32768
v_mul_f32 v18, v18, v70
v_mul_f32 v19, v19, v71
v_exp_f32 v16, v16
s_waitcnt lgkmcnt(5)
v_mfma_f32_32x32x16_bf16 v[80:95], v[204:207], v[44:47], v[80:95]
ds_read_b128 v[36:39], v7 offset:32768
v_exp_f32 v17, v17
s_add_u32 m0, s74, 53248
s_waitcnt lgkmcnt(5)
v_mfma_f32_32x32x16_bf16 v[80:95], v[208:211], v[48:51], v[80:95]
ds_read_b128 v[40:43], v8 offset:32768
buffer_load_dwordx4 v10, s[4:7], s83 offen sc1 lds
v_exp_f32 v18, v18
s_waitcnt lgkmcnt(5)
v_mfma_f32_32x32x16_bf16 v[80:95], v[212:215], v[52:55], v[80:95]
ds_read_b128 v[44:47], v9 offset:32768
v_exp_f32 v19, v19
s_waitcnt lgkmcnt(5)
v_mfma_f32_32x32x16_bf16 v[80:95], v[216:219], v[56:59], v[80:95]
ds_read_b128 v[48:51], v6 offset:36864
v_add_f32 v16, 1.0, v16
v_add_f32 v17, 1.0, v17
s_waitcnt lgkmcnt(5)
v_mfma_f32_32x32x16_bf16 v[80:95], v[220:223], v[60:63], v[80:95]
ds_read_b128 v[52:55], v7 offset:36864
v_add_f32 v18, 1.0, v18
v_add_f32 v19, 1.0, v19
s_add_u32 m0, s74, 57344
s_waitcnt lgkmcnt(5)
v_mfma_f32_32x32x16_bf16 v[80:95], v[224:227], v[32:35], v[80:95]
ds_read_b128 v[56:59], v8 offset:36864
buffer_load_dwordx4 v10, s[4:7], s84 offen sc1 lds
v_rcp_f32 v16, v16
s_waitcnt lgkmcnt(5)
v_mfma_f32_32x32x16_bf16 v[80:95], v[228:231], v[36:39], v[80:95]
ds_read_b128 v[60:63], v9 offset:36864
v_rcp_f32 v17, v17
s_waitcnt lgkmcnt(5)
v_mfma_f32_32x32x16_bf16 v[80:95], v[232:235], v[40:43], v[80:95]
v_rcp_f32 v18, v18
v_rcp_f32 v19, v19
s_waitcnt lgkmcnt(4)
v_mfma_f32_32x32x16_bf16 v[80:95], v[236:239], v[44:47], v[80:95]
v_mul_f32 v76, v76, v16
s_add_u32 m0, s74, 61440
s_waitcnt lgkmcnt(3)
v_mfma_f32_32x32x16_bf16 v[80:95], v[240:243], v[48:51], v[80:95]
s_waitcnt vmcnt(10) lgkmcnt(0)
s_barrier
ds_read_b128 v[32:35], v2 offset:0
ds_read_b128 v[36:39], v3 offset:0
ds_read_b128 v[40:43], v4 offset:0
buffer_load_dwordx4 v10, s[4:7], s85 offen sc1 lds
v_mul_f32 v77, v77, v17
v_mul_f32 v78, v78, v18
s_waitcnt lgkmcnt(5)
v_mfma_f32_32x32x16_bf16 v[80:95], v[244:247], v[52:55], v[80:95]
ds_read_b128 v[44:47], v5 offset:0
v_mul_f32 v79, v79, v19
v_cvt_pk_bf16_f32 v26, v76, v77
s_waitcnt lgkmcnt(5)
v_mfma_f32_32x32x16_bf16 v[80:95], v[248:251], v[56:59], v[80:95]
ds_read_b128 v[48:51], v2 offset:4096
v_cvt_pk_bf16_f32 v27, v78, v79
buffer_store_dwordx4 v[24:27], v11, s[16:19], s78 offen sc1
s_waitcnt lgkmcnt(5)
v_mfma_f32_32x32x16_bf16 v[80:95], v[252:255], v[60:63], v[80:95]
ds_read_b128 v[52:55], v3 offset:4096
s_add_u32 s78, s78, 98304
s_cmp_eq_u32 s78, s29
s_cselect_b32 s78, s28, s78
s_sub_u32 s79, s79, 1
s_cmp_lg_u32 s79, 0
s_cbranch_scc1 L_g1top_4
L_g1tail_3:
s_add_u32 m0, s74, 65536
s_nop 0
buffer_load_dwordx4 v10, s[4:7], s86 offen sc1 lds
s_add_u32 m0, s74, 69632
s_nop 0
buffer_load_dwordx4 v10, s[4:7], s87 offen sc1 lds
s_add_u32 m0, s74, 73728
s_nop 0
buffer_load_dwordx4 v10, s[4:7], s88 offen sc1 lds
s_add_u32 m0, s74, 77824
s_nop 0
buffer_load_dwordx4 v10, s[4:7], s89 offen sc1 lds
s_waitcnt lgkmcnt(0)
s_mul_i32 s70, s66, 3072
s_add_u32 s70, s70, 8192
v_min_u32 v42, 23, v0
v_lshl_add_u32 v42, v42, 7, s70
buffer_load_dword v43, v42, s[24:27], 0 offen sc1
s_nop 4
v_mul_f32 v16, v80, v80
v_mul_f32 v17, v81, v81
v_mul_f32 v18, v82, v82
v_mul_f32 v19, v83, v83
v_mul_f32 v88, v80, v88
v_mul_f32 v89, v81, v89
v_mul_f32 v90, v82, v90
v_mul_f32 v91, v83, v91
v_fmaak_f32 v16, v12, v16, 0xc0135761
v_fmaak_f32 v17, v12, v17, 0xc0135761
v_fmaak_f32 v18, v12, v18, 0xc0135761
v_fmaak_f32 v19, v12, v19, 0xc0135761
v_mul_f32 v16, v16, v80
v_mul_f32 v17, v17, v81
v_mul_f32 v18, v18, v82
v_mul_f32 v19, v19, v83
v_exp_f32 v16, v16
v_exp_f32 v17, v17
v_exp_f32 v18, v18
v_exp_f32 v19, v19
v_add_f32 v16, 1.0, v16
v_add_f32 v17, 1.0, v17
v_add_f32 v18, 1.0, v18
v_add_f32 v19, 1.0, v19
v_rcp_f32 v16, v16
v_rcp_f32 v17, v17
v_rcp_f32 v18, v18
v_rcp_f32 v19, v19
v_mul_f32 v88, v88, v16
v_mul_f32 v89, v89, v17
v_mul_f32 v90, v90, v18
v_mul_f32 v91, v91, v19
v_cvt_pk_bf16_f32 v24, v88, v89
v_cvt_pk_bf16_f32 v25, v90, v91
v_mul_f32 v16, v84, v84
v_mul_f32 v17, v85, v85
v_mul_f32 v18, v86, v86
v_mul_f32 v19, v87, v87
v_mul_f32 v92, v84, v92
v_mul_f32 v93, v85, v93
v_mul_f32 v94, v86, v94
v_mul_f32 v95, v87, v95
v_fmaak_f32 v16, v12, v16, 0xc0135761
v_fmaak_f32 v17, v12, v17, 0xc0135761
v_fmaak_f32 v18, v12, v18, 0xc0135761
v_fmaak_f32 v19, v12, v19, 0xc0135761
v_mul_f32 v16, v16, v84
v_mul_f32 v17, v17, v85
v_mul_f32 v18, v18, v86
v_mul_f32 v19, v19, v87
v_exp_f32 v16, v16
v_exp_f32 v17, v17
v_exp_f32 v18, v18
v_exp_f32 v19, v19
v_add_f32 v16, 1.0, v16
v_add_f32 v17, 1.0, v17
v_add_f32 v18, 1.0, v18
v_add_f32 v19, 1.0, v19
v_rcp_f32 v16, v16
v_rcp_f32 v17, v17
v_rcp_f32 v18, v18
v_rcp_f32 v19, v19
v_mul_f32 v92, v92, v16
v_mul_f32 v93, v93, v17
v_mul_f32 v94, v94, v18
v_mul_f32 v95, v95, v19
v_cvt_pk_bf16_f32 v26, v92, v93
v_cvt_pk_bf16_f32 v27, v94, v95
buffer_store_dwordx4 v[24:27], v11, s[16:19], s78 offen sc1
s_add_u32 s78, s78, 98304
s_cmp_eq_u32 s78, s29
s_cselect_b32 s78, s28, s78
s_branch L_g1end_7
L_g1tail_2:
s_add_u32 m0, s74, 24576
s_nop 0
buffer_load_dwordx4 v10, s[4:7], s86 offen sc1 lds
s_add_u32 m0, s74, 28672
s_nop 0
buffer_load_dwordx4 v10, s[4:7], s87 offen sc1 lds
s_add_u32 m0, s74, 32768
s_nop 0
buffer_load_dwordx4 v10, s[4:7], s88 offen sc1 lds
s_add_u32 m0, s74, 36864
s_nop 0
buffer_load_dwordx4 v10, s[4:7], s89 offen sc1 lds
s_waitcnt lgkmcnt(0)
s_mul_i32 s70, s66, 3072
s_add_u32 s70, s70, 8192
v_min_u32 v42, 23, v0
v_lshl_add_u32 v42, v42, 7, s70
buffer_load_dword v43, v42, s[24:27], 0 offen sc1
s_nop 4
v_mul_f32 v16, v64, v64
v_mul_f32 v17, v65, v65
v_mul_f32 v18, v66, v66
v_mul_f32 v19, v67, v67
v_mul_f32 v72, v64, v72
v_mul_f32 v73, v65, v73
v_mul_f32 v74, v66, v74
v_mul_f32 v75, v67, v75
v_fmaak_f32 v16, v12, v16, 0xc0135761
v_fmaak_f32 v17, v12, v17, 0xc0135761
v_fmaak_f32 v18, v12, v18, 0xc0135761
v_fmaak_f32 v19, v12, v19, 0xc0135761
v_mul_f32 v16, v16, v64
v_mul_f32 v17, v17, v65
v_mul_f32 v18, v18, v66
v_mul_f32 v19, v19, v67
v_exp_f32 v16, v16
v_exp_f32 v17, v17
v_exp_f32 v18, v18
v_exp_f32 v19, v19
v_add_f32 v16, 1.0, v16
v_add_f32 v17, 1.0, v17
v_add_f32 v18, 1.0, v18
v_add_f32 v19, 1.0, v19
v_rcp_f32 v16, v16
v_rcp_f32 v17, v17
v_rcp_f32 v18, v18
v_rcp_f32 v19, v19
v_mul_f32 v72, v72, v16
v_mul_f32 v73, v73, v17
v_mul_f32 v74, v74, v18
v_mul_f32 v75, v75, v19
v_cvt_pk_bf16_f32 v24, v72, v73
v_cvt_pk_bf16_f32 v25, v74, v75
v_mul_f32 v16, v68, v68
v_mul_f32 v17, v69, v69
v_mul_f32 v18, v70, v70
v_mul_f32 v19, v71, v71
v_mul_f32 v76, v68, v76
v_mul_f32 v77, v69, v77
v_mul_f32 v78, v70, v78
v_mul_f32 v79, v71, v79
v_fmaak_f32 v16, v12, v16, 0xc0135761
v_fmaak_f32 v17, v12, v17, 0xc0135761
v_fmaak_f32 v18, v12, v18, 0xc0135761
v_fmaak_f32 v19, v12, v19, 0xc0135761
v_mul_f32 v16, v16, v68
v_mul_f32 v17, v17, v69
v_mul_f32 v18, v18, v70
v_mul_f32 v19, v19, v71
v_exp_f32 v16, v16
v_exp_f32 v17, v17
v_exp_f32 v18, v18
v_exp_f32 v19, v19
v_add_f32 v16, 1.0, v16
v_add_f32 v17, 1.0, v17
v_add_f32 v18, 1.0, v18
v_add_f32 v19, 1.0, v19
v_rcp_f32 v16, v16
v_rcp_f32 v17, v17
v_rcp_f32 v18, v18
v_rcp_f32 v19, v19
v_mul_f32 v76, v76, v16
v_mul_f32 v77, v77, v17
v_mul_f32 v78, v78, v18
v_mul_f32 v79, v79, v19
v_cvt_pk_bf16_f32 v26, v76, v77
v_cvt_pk_bf16_f32 v27, v78, v79
buffer_store_dwordx4 v[24:27], v11, s[16:19], s78 offen sc1
s_add_u32 s78, s78, 98304
s_cmp_eq_u32 s78, s29
s_cselect_b32 s78, s28, s78
L_g1end_7:
s_cmp_ge_u32 s67, 12
s_cbranch_scc1 L_g1z_8
s_waitcnt vmcnt(0) lgkmcnt(0)
s_barrier
s_cmp_lg_u32 s66, 0
s_cbranch_scc1 L_pub_9
v_mov_b32 v31, s1
s_mov_b64 exec, 1
buffer_store_dword v31, v1, s[24:27], s91 offen sc1
s_mov_b64 exec, -1
L_pub_9:
s_branch L_done
L_g1z_8:
s_mov_b32 s0, s91
s_cmp_lg_u32 s50, 0
s_cbranch_scc1 L_wdok_10
s_waitcnt vmcnt(1)
s_mov_b32 s72, 7389
v_cmp_ne_u32 vcc, s1, v43
s_cbranch_vccz L_pollok_12
L_poll_11:
buffer_load_dword v43, v42, s[24:27], 0 offen sc1
s_waitcnt vmcnt(0)
v_cmp_ne_u32 vcc, s1, v43
s_cbranch_vccz L_pollok_12
s_sleep 16
s_sub_u32 s72, s72, 1
s_cbranch_scc0 L_poll_11
L_pollok_12:
L_wdok_10:
s_setprio 1
s_branch L_g2
L_prepC:
s_lshl_b32 s69, s3, 1
s_add_u32 s69, s69, s67
s_sub_u32 s69, s69, 30
s_and_b32 s69, s3, 1
s_lshl_b32 s69, s69, 3
s_and_b32 s70, s3, 6
s_add_u32 s69, s69, s70
s_add_u32 s69, s69, s67
s_sub_u32 s69, s69, 30
s_lshl_b32 s79, s69, 7
s_add_u32 s79, s79, 4096
s_lshl_b32 s69, s69, 2
s_add_u32 s69, s69, s66
s_mul_i32 s88, s69, 40960
s_lshl_b32 s89, s69, 8
v_lshrrev_b32 v63, 5, v0
v_and_b32 v62, 31, v0
v_lshlrev_b32 v62, 4, v62
v_mul_u32_u24 v56, 1280, v63
v_add_u32 v56, v56, v62
v_lshlrev_b32 v63, 3, v63
v_and_b32 v61, 15, v0
v_lshl_add_u32 v63, v61, 4, v63
v_mov_b32 v8, 0
s_mov_b32 s71, 0
s_mov_b32 s82, 2621440
s_mov_b32 s83, 0x20000
s_mov_b32 s86, 1280
s_mov_b32 s87, 0x20000
v_mov_b32 v72, 0
v_mov_b32 v84, 0
v_mov_b32 v96, 0
v_mov_b32 v108, 0
v_mov_b32 v24, 0
v_mov_b32 v73, 0
v_mov_b32 v85, 0
v_mov_b32 v97, 0
v_mov_b32 v109, 0
v_mov_b32 v25, 0
v_mov_b32 v74, 0
v_mov_b32 v86, 0
v_mov_b32 v98, 0
v_mov_b32 v110, 0
v_mov_b32 v26, 0
v_mov_b32 v75, 0
v_mov_b32 v87, 0
v_mov_b32 v99, 0
v_mov_b32 v111, 0
v_mov_b32 v27, 0
s_waitcnt lgkmcnt(0)
s_load_dword s1, s[64:65], 0
s_mov_b64 s[80:81], s[36:37]
s_mov_b64 s[84:85], s[58:59]
buffer_load_dwordx4 v[16:19], v62, s[84:87], 0 offen
buffer_load_dwordx4 v[20:23], v62, s[84:87], 0 offen offset:512
s_mov_b32 exec_lo, 0xffff
s_mov_b32 exec_hi, 0xffff
buffer_load_dwordx4 v[24:27], v62, s[84:87], 0 offen offset:1024
s_mov_b64 exec, -1
buffer_load_dwordx4 v[64:67], v56, s[80:83], s88 offen
buffer_load_dwordx4 v[68:71], v56, s[80:83], s88 offen offset:512
s_mov_b32 exec_lo, 0xffff
s_mov_b32 exec_hi, 0xffff
buffer_load_dwordx4 v[72:75], v56, s[80:83], s88 offen offset:1024
s_mov_b64 exec, -1
s_add_u32 s88, s88, 2560
buffer_load_dwordx4 v[76:79], v56, s[80:83], s88 offen
buffer_load_dwordx4 v[80:83], v56, s[80:83], s88 offen offset:512
s_mov_b32 exec_lo, 0xffff
s_mov_b32 exec_hi, 0xffff
buffer_load_dwordx4 v[84:87], v56, s[80:83], s88 offen offset:1024
s_mov_b64 exec, -1
s_add_u32 s88, s88, 2560
buffer_load_dwordx4 v[88:91], v56, s[80:83], s88 offen
buffer_load_dwordx4 v[92:95], v56, s[80:83], s88 offen offset:512
s_mov_b32 exec_lo, 0xffff
s_mov_b32 exec_hi, 0xffff
buffer_load_dwordx4 v[96:99], v56, s[80:83], s88 offen offset:1024
s_mov_b64 exec, -1
s_add_u32 s88, s88, 2560
buffer_load_dwordx4 v[100:103], v56, s[80:83], s88 offen
buffer_load_dwordx4 v[104:107], v56, s[80:83], s88 offen offset:512
s_mov_b32 exec_lo, 0xffff
s_mov_b32 exec_hi, 0xffff
buffer_load_dwordx4 v[108:111], v56, s[80:83], s88 offen offset:1024
s_mov_b64 exec, -1
s_add_u32 s88, s88, 2560
s_add_u32 s16, s64, 15728640
s_addc_u32 s17, s65, 0
s_mov_b32 s18, 16384
s_mov_b32 s19, 0x20000
s_mov_b32 s24, s64
s_mov_b32 s25, s65
s_mov_b32 s26, 114688
s_mov_b32 s27, 0x20000
s_mov_b32 s70, 3
L_gl_13:
s_cmp_eq_u32 s70, 0
s_cselect_b32 s88, 0x8000000, s88
s_waitcnt vmcnt(9)
v_mov_b32 v52, 0
v_dot2_f32_bf16 v52, v64, v16, v52
v_dot2_f32_bf16 v52, v65, v17, v52
v_dot2_f32_bf16 v52, v66, v18, v52
v_dot2_f32_bf16 v52, v67, v19, v52
v_dot2_f32_bf16 v52, v68, v20, v52
v_dot2_f32_bf16 v52, v69, v21, v52
v_dot2_f32_bf16 v52, v70, v22, v52
v_dot2_f32_bf16 v52, v71, v23, v52
v_dot2_f32_bf16 v52, v72, v24, v52
v_dot2_f32_bf16 v52, v73, v25, v52
v_dot2_f32_bf16 v52, v74, v26, v52
v_dot2_f32_bf16 v52, v75, v27, v52
s_nop 2
v_add_f32_dpp v52, v52, v52 row_ror:8 row_mask:0xf bank_mask:0xf
s_nop 1
v_add_f32_dpp v52, v52, v52 row_ror:4 row_mask:0xf bank_mask:0xf
s_nop 1
v_add_f32_dpp v52, v52, v52 row_ror:2 row_mask:0xf bank_mask:0xf
s_nop 1
v_add_f32_dpp v52, v52, v52 row_ror:1 row_mask:0xf bank_mask:0xf
s_nop 1
v_add_f32_dpp v52, v52, v52 row_bcast:15 row_mask:0xa bank_mask:0xf
buffer_load_dwordx4 v[64:67], v56, s[80:83], s88 offen
buffer_load_dwordx4 v[68:71], v56, s[80:83], s88 offen offset:512
s_mov_b32 exec_lo, 0xffff
s_mov_b32 exec_hi, 0xffff
buffer_load_dwordx4 v[72:75], v56, s[80:83], s88 offen offset:1024
s_mov_b64 exec, -1
s_add_u32 s88, s88, 2560
v_cmp_eq_u32 vcc, s71, v61
s_nop 1
v_cndmask_b32 v53, v53, v52, vcc
s_add_u32 s71, s71, 1
s_waitcnt vmcnt(9)
v_mov_b32 v52, 0
v_dot2_f32_bf16 v52, v76, v16, v52
v_dot2_f32_bf16 v52, v77, v17, v52
v_dot2_f32_bf16 v52, v78, v18, v52
v_dot2_f32_bf16 v52, v79, v19, v52
v_dot2_f32_bf16 v52, v80, v20, v52
v_dot2_f32_bf16 v52, v81, v21, v52
v_dot2_f32_bf16 v52, v82, v22, v52
v_dot2_f32_bf16 v52, v83, v23, v52
v_dot2_f32_bf16 v52, v84, v24, v52
v_dot2_f32_bf16 v52, v85, v25, v52
v_dot2_f32_bf16 v52, v86, v26, v52
v_dot2_f32_bf16 v52, v87, v27, v52
s_nop 2
v_add_f32_dpp v52, v52, v52 row_ror:8 row_mask:0xf bank_mask:0xf
s_nop 1
v_add_f32_dpp v52, v52, v52 row_ror:4 row_mask:0xf bank_mask:0xf
s_nop 1
v_add_f32_dpp v52, v52, v52 row_ror:2 row_mask:0xf bank_mask:0xf
s_nop 1
v_add_f32_dpp v52, v52, v52 row_ror:1 row_mask:0xf bank_mask:0xf
s_nop 1
v_add_f32_dpp v52, v52, v52 row_bcast:15 row_mask:0xa bank_mask:0xf
buffer_load_dwordx4 v[76:79], v56, s[80:83], s88 offen
buffer_load_dwordx4 v[80:83], v56, s[80:83], s88 offen offset:512
s_mov_b32 exec_lo, 0xffff
s_mov_b32 exec_hi, 0xffff
buffer_load_dwordx4 v[84:87], v56, s[80:83], s88 offen offset:1024
s_mov_b64 exec, -1
s_add_u32 s88, s88, 2560
v_cmp_eq_u32 vcc, s71, v61
s_nop 1
v_cndmask_b32 v53, v53, v52, vcc
s_add_u32 s71, s71, 1
s_waitcnt vmcnt(9)
v_mov_b32 v52, 0
v_dot2_f32_bf16 v52, v88, v16, v52
v_dot2_f32_bf16 v52, v89, v17, v52
v_dot2_f32_bf16 v52, v90, v18, v52
v_dot2_f32_bf16 v52, v91, v19, v52
v_dot2_f32_bf16 v52, v92, v20, v52
v_dot2_f32_bf16 v52, v93, v21, v52
v_dot2_f32_bf16 v52, v94, v22, v52
v_dot2_f32_bf16 v52, v95, v23, v52
v_dot2_f32_bf16 v52, v96, v24, v52
v_dot2_f32_bf16 v52, v97, v25, v52
v_dot2_f32_bf16 v52, v98, v26, v52
v_dot2_f32_bf16 v52, v99, v27, v52
s_nop 2
v_add_f32_dpp v52, v52, v52 row_ror:8 row_mask:0xf bank_mask:0xf
s_nop 1
v_add_f32_dpp v52, v52, v52 row_ror:4 row_mask:0xf bank_mask:0xf
s_nop 1
v_add_f32_dpp v52, v52, v52 row_ror:2 row_mask:0xf bank_mask:0xf
s_nop 1
v_add_f32_dpp v52, v52, v52 row_ror:1 row_mask:0xf bank_mask:0xf
s_nop 1
v_add_f32_dpp v52, v52, v52 row_bcast:15 row_mask:0xa bank_mask:0xf
buffer_load_dwordx4 v[88:91], v56, s[80:83], s88 offen
buffer_load_dwordx4 v[92:95], v56, s[80:83], s88 offen offset:512
s_mov_b32 exec_lo, 0xffff
s_mov_b32 exec_hi, 0xffff
buffer_load_dwordx4 v[96:99], v56, s[80:83], s88 offen offset:1024
s_mov_b64 exec, -1
s_add_u32 s88, s88, 2560
v_cmp_eq_u32 vcc, s71, v61
s_nop 1
v_cndmask_b32 v53, v53, v52, vcc
s_add_u32 s71, s71, 1
s_waitcnt vmcnt(9)
v_mov_b32 v52, 0
v_dot2_f32_bf16 v52, v100, v16, v52
v_dot2_f32_bf16 v52, v101, v17, v52
v_dot2_f32_bf16 v52, v102, v18, v52
v_dot2_f32_bf16 v52, v103, v19, v52
v_dot2_f32_bf16 v52, v104, v20, v52
v_dot2_f32_bf16 v52, v105, v21, v52
v_dot2_f32_bf16 v52, v106, v22, v52
v_dot2_f32_bf16 v52, v107, v23, v52
v_dot2_f32_bf16 v52, v108, v24, v52
v_dot2_f32_bf16 v52, v109, v25, v52
v_dot2_f32_bf16 v52, v110, v26, v52
v_dot2_f32_bf16 v52, v111, v27, v52
s_nop 2
v_add_f32_dpp v52, v52, v52 row_ror:8 row_mask:0xf bank_mask:0xf
s_nop 1
v_add_f32_dpp v52, v52, v52 row_ror:4 row_mask:0xf bank_mask:0xf
s_nop 1
v_add_f32_dpp v52, v52, v52 row_ror:2 row_mask:0xf bank_mask:0xf
s_nop 1
v_add_f32_dpp v52, v52, v52 row_ror:1 row_mask:0xf bank_mask:0xf
s_nop 1
v_add_f32_dpp v52, v52, v52 row_bcast:15 row_mask:0xa bank_mask:0xf
buffer_load_dwordx4 v[100:103], v56, s[80:83], s88 offen
buffer_load_dwordx4 v[104:107], v56, s[80:83], s88 offen offset:512
s_mov_b32 exec_lo, 0xffff
s_mov_b32 exec_hi, 0xffff
buffer_load_dwordx4 v[108:111], v56, s[80:83], s88 offen offset:1024
s_mov_b64 exec, -1
s_add_u32 s88, s88, 2560
v_cmp_eq_u32 vcc, s71, v61
s_nop 1
v_cndmask_b32 v53, v53, v52, vcc
s_add_u32 s71, s71, 1
s_sub_u32 s70, s70, 1
s_cbranch_scc0 L_gl_13
s_waitcnt lgkmcnt(0)
v_cvt_pk_bf16_f32 v53, v53, v53
v_lshlrev_b32 v53, 16, v53
v_mul_f32 v53, 0xbfb8aa3b, v53
v_exp_f32 v53, v53
s_nop 0
v_add_f32 v53, 1.0, v53
v_rcp_f32 v53, v53
s_nop 0
v_cvt_pk_bf16_f32 v53, v53, v53
v_lshlrev_b32 v54, 16, v53
v_sub_f32 v53, 1.0, v54
v_cvt_pk_bf16_f32 v53, v53, v53
v_lshlrev_b32 v55, 16, v53
s_mov_b32 exec_lo, 0xffff0000
s_mov_b32 exec_hi, 0xffff0000
buffer_store_dwordx2 v[54:55], v63, s[16:19], s89 offen sc1
s_mov_b64 exec, -1
s_mul_i32 s1, s1, 0x9e3779b1
s_add_u32 s1, s1, 0x7f4a7c15
s_or_b32 s1, s1, 1
s_waitcnt vmcnt(0)
s_barrier
s_cmp_lg_u32 s66, 0
s_cbranch_scc1 L_pub_14
v_mov_b32 v9, s1
s_mov_b64 exec, 1
buffer_store_dword v9, v8, s[24:27], s79 offen sc1
s_mov_b64 exec, -1
L_pub_14:
s_mul_i32 s70, s66, 3072
s_add_u32 s70, s70, 8192
v_min_u32 v42, 23, v0
v_lshl_add_u32 v42, v42, 7, s70
s_mov_b32 s72, 7389
L_poll_15:
buffer_load_dword v16, v42, s[24:27], 0 offen sc1
s_waitcnt vmcnt(0)
v_cmp_ne_u32 vcc, s1, v16
s_cbranch_vccz L_pollok_16
s_sleep 16
s_sub_u32 s72, s72, 1
s_cbranch_scc0 L_poll_15
L_pollok_16:
s_mov_b32 s0, 0
s_mov_b32 s50, 0
s_branch L_g2
L_half1:
s_cmp_ge_u32 s67, 12
s_cbranch_scc1 L_ssm
s_setprio 3
s_mul_i32 s68, s3, 12
s_add_u32 s68, s68, s67
s_mul_i32 s90, s68, 20480
s_mul_i32 s89, s66, 2560
s_add_u32 s90, s90, s89
s_mov_b32 s6, 1966080
s_mov_b32 s7, 0x20000
v_lshrrev_b32 v61, 5, v0
v_and_b32 v62, 31, v0
v_lshlrev_b32 v62, 4, v62
v_mul_u32_u24 v56, 1280, v61
v_add_u32 v56, v56, v62
s_waitcnt lgkmcnt(0)
s_load_dword s1, s[64:65], 0
s_mov_b64 s[4:5], s[56:57]
buffer_load_dwordx4 v[64:67], v56, s[4:7], s90 offen
buffer_load_dwordx4 v[68:71], v56, s[4:7], s90 offen offset:512
s_mov_b32 exec_lo, 0xffff
s_mov_b32 exec_hi, 0xffff
buffer_load_dwordx4 v[72:75], v56, s[4:7], s90 offen offset:1024
s_mov_b64 exec, -1
s_add_u32 s90, s90, 10240
buffer_load_dwordx4 v[76:79], v56, s[4:7], s90 offen
buffer_load_dwordx4 v[80:83], v56, s[4:7], s90 offen offset:512
s_mov_b32 exec_lo, 0xffff
s_mov_b32 exec_hi, 0xffff
buffer_load_dwordx4 v[84:87], v56, s[4:7], s90 offen offset:1024
s_mov_b64 exec, -1
v_mul_u32_u24 v57, 1296, v61
v_add_u32 v57, v57, v62
s_mul_i32 s70, s66, 20480
v_add_u32 v57, s70, v57
v_bfe_u32 v58, v0, 3, 1
v_mul_u32_u24 v58, 20480, v58
v_bfe_u32 v59, v0, 2, 1
v_mul_u32_u24 v59, 1296, v59
v_add_u32 v58, v58, v59
v_lshrrev_b32 v60, 4, v0
v_lshl_add_u32 v58, v60, 5, v58
v_and_b32 v59, 3, v0
v_lshl_add_u32 v58, v59, 3, v58
s_lshl_b32 s70, s66, 7
v_add_u32 v58, s70, v58
v_mul_u32_u24 v60, 49152, v60
v_and_b32 v59, 15, v0
v_lshl_add_u32 v60, v59, 4, v60
v_mov_b32 v61, 0
s_add_u32 s8, s64, 12582912
s_addc_u32 s9, s65, 0
s_mov_b32 s10, 1966080
s_mov_b32 s11, 0x20000
s_mov_b32 s24, s64
s_mov_b32 s25, s65
s_mov_b32 s26, 114688
s_mov_b32 s27, 0x20000
v_lshlrev_b32 v40, 7, v0
v_min_u32 v41, 19, v0
s_mul_i32 s70, s3, 2560
s_add_u32 s70, s70, 55296
v_lshl_add_u32 v41, v41, 7, s70
s_mul_i32 s70, s66, 3072
s_add_u32 s70, s70, 8192
v_min_u32 v42, 23, v0
v_lshl_add_u32 v42, v42, 7, s70
s_lshl_b32 s78, s68, 7
s_add_u32 s78, s78, 8192
s_lshr_b32 s90, s68, 1
s_lshl_b32 s90, s90, 10
s_and_b32 s70, s68, 1
s_lshl_b32 s70, s70, 9
s_add_u32 s90, s90, s70
s_mul_i32 s70, s66, 196608
s_add_u32 s90, s90, s70
s_waitcnt vmcnt(3)
ds_write_b128 v57, v[64:67] offset:0
ds_write_b128 v57, v[68:71] offset:512
s_mov_b32 exec_lo, 0xffff
s_mov_b32 exec_hi, 0xffff
ds_write_b128 v57, v[72:75] offset:1024
s_mov_b64 exec, -1
s_waitcnt vmcnt(0)
ds_write_b128 v57, v[76:79] offset:2688
ds_write_b128 v57, v[80:83] offset:3200
s_mov_b32 exec_lo, 0xffff
s_mov_b32 exec_hi, 0xffff
ds_write_b128 v57, v[84:87] offset:3712
s_mov_b64 exec, -1
s_waitcnt lgkmcnt(0)
s_barrier
s_add_u32 s91, s90, 0
ds_read_b64_tr_b16 v[128:129], v58 offset:0
ds_read_b64_tr_b16 v[130:131], v58 offset:40960
ds_read_b64_tr_b16 v[132:133], v58 offset:512
ds_read_b64_tr_b16 v[134:135], v58 offset:41472
ds_read_b64_tr_b16 v[136:137], v58 offset:1024
ds_read_b64_tr_b16 v[138:139], v58 offset:41984
s_waitcnt lgkmcnt(4)
buffer_store_dwordx4 v[128:131], v60, s[8:11], s91 offen sc1
s_add_u32 s91, s91, 786432
s_waitcnt lgkmcnt(2)
buffer_store_dwordx4 v[132:135], v60, s[8:11], s91 offen sc1
s_add_u32 s91, s91, 786432
s_cmp_ge_u32 s66, 2
s_cbranch_scc1 L_p8s_17
s_waitcnt lgkmcnt(0)
buffer_store_dwordx4 v[136:139], v60, s[8:11], s91 offen sc1
L_p8s_17:
s_waitcnt lgkmcnt(0)
s_add_u32 s91, s90, 256
ds_read_b64_tr_b16 v[140:141], v58 offset:2688
ds_read_b64_tr_b16 v[142:143], v58 offset:43648
ds_read_b64_tr_b16 v[144:145], v58 offset:3200
ds_read_b64_tr_b16 v[146:147], v58 offset:44160
ds_read_b64_tr_b16 v[148:149], v58 offset:3712
ds_read_b64_tr_b16 v[150:151], v58 offset:44672
s_waitcnt lgkmcnt(4)
buffer_store_dwordx4 v[140:143], v60, s[8:11], s91 offen sc1
s_add_u32 s91, s91, 786432
s_waitcnt lgkmcnt(2)
buffer_store_dwordx4 v[144:147], v60, s[8:11], s91 offen sc1
s_add_u32 s91, s91, 786432
s_cmp_ge_u32 s66, 2
s_cbranch_scc1 L_p8s_18
s_waitcnt lgkmcnt(0)
buffer_store_dwordx4 v[148:151], v60, s[8:11], s91 offen sc1
L_p8s_18:
s_waitcnt lgkmcnt(0)
s_mul_i32 s1, s1, 0x9e3779b1
s_add_u32 s1, s1, 0x7f4a7c15
s_or_b32 s1, s1, 1
s_waitcnt vmcnt(0)
s_barrier
s_cmp_lg_u32 s66, 0
s_cbranch_scc1 L_pub_19
v_mov_b32 v16, s1
s_mov_b64 exec, 1
buffer_store_dword v16, v61, s[24:27], s78 offen sc1
s_mov_b64 exec, -1
L_pub_19:
s_setprio 0
s_mul_i32 s70, s67, 43
s_lshr_b32 s70, s70, 8
s_mul_i32 s71, s70, 18
s_add_u32 s71, s71, s67
s_and_b32 s70, s3, 1
s_mul_i32 s70, s70, 120
s_add_u32 s71, s71, s70
s_lshr_b32 s70, s3, 1
s_mul_i32 s70, s70, 6
s_add_u32 s71, s71, s70
s_lshl_b32 s71, s71, 7
s_add_u32 s71, s71, 81920
v_mov_b32 v41, s71
s_mov_b32 s72, 2555
L_poll_20:
buffer_load_dword v16, v41, s[24:27], 0 offen sc1
s_waitcnt vmcnt(0)
v_cmp_ne_u32 vcc, s1, v16
s_cbranch_vccz L_pollok_21
s_sleep 64
s_sub_u32 s72, s72, 1
s_cbranch_scc0 L_poll_20
L_pollok_21:
s_mov_b32 s72, 7389
L_poll_22:
buffer_load_dword v16, v42, s[24:27], 0 offen sc1
s_waitcnt vmcnt(0)
v_cmp_ne_u32 vcc, s1, v16
s_cbranch_vccz L_pollok_23
s_sleep 16
s_sub_u32 s72, s72, 1
s_cbranch_scc0 L_poll_22
L_pollok_23:
s_barrier
s_mov_b32 s0, 0
s_mov_b32 s50, 0
s_branch L_g2
L_ssm:
s_mul_i32 s68, s3, 20
s_add_u32 s68, s68, s67
s_sub_u32 s68, s68, 12
s_setprio 3
s_lshl_b32 s70, s68, 2
s_add_u32 s70, s70, s66
s_mul_i32 s71, s70, 384
s_lshl_b32 s72, s70, 1
v_lshlrev_b32 v1, 2, v0
v_lshlrev_b32 v2, 1, v0
v_mov_b32 v3, 0
s_mul_i32 s76, s66, 20480
s_mov_b32 m0, s76
s_add_u32 s78, s76, 5760
s_mov_b32 s10, 245760
s_mov_b32 s11, 0x20000
s_mov_b32 s14, 245760
s_mov_b32 s15, 0x20000
s_mov_b32 s18, 245760
s_mov_b32 s19, 0x20000
s_mov_b32 s22, 245760
s_mov_b32 s23, 0x20000
s_mov_b32 s6, 1280
s_mov_b32 s7, 0x20000
s_mov_b32 s34, 1280
s_mov_b32 s35, 0x20000
v_and_b32 v45, 15, v0
v_lshrrev_b32 v40, 4, v0
v_lshlrev_b32 v41, 3, v40
v_sub_u32 v42, v41, v45
v_add_u32 v42, 16, v42
v_min_u32 v42, 31, v42
s_mov_b32 s79, 939524096
v_lshrrev_b32 v43, v42, s79
v_bfe_u32 v44, v43, 0, 1
v_bfe_u32 v46, v43, 1, 1
v_lshl_or_b32 v44, v46, 16, v44
v_mul_u32_u24 v216, 0x3f80, v44
v_bfe_u32 v44, v43, 2, 1
v_bfe_u32 v46, v43, 3, 1
v_lshl_or_b32 v44, v46, 16, v44
v_mul_u32_u24 v217, 0x3f80, v44
v_bfe_u32 v44, v43, 4, 1
v_bfe_u32 v46, v43, 5, 1
v_lshl_or_b32 v44, v46, 16, v44
v_mul_u32_u24 v218, 0x3f80, v44
v_bfe_u32 v44, v43, 6, 1
v_bfe_u32 v46, v43, 7, 1
v_lshl_or_b32 v44, v46, 16, v44
v_mul_u32_u24 v219, 0x3f80, v44
s_mov_b32 s79, 3670016
v_lshrrev_b32 v43, v42, s79
v_bfe_u32 v44, v43, 0, 1
v_bfe_u32 v46, v43, 1, 1
v_lshl_or_b32 v44, v46, 16, v44
v_mul_u32_u24 v220, 0x3f80, v44
v_bfe_u32 v44, v43, 2, 1
v_bfe_u32 v46, v43, 3, 1
v_lshl_or_b32 v44, v46, 16, v44
v_mul_u32_u24 v221, 0x3f80, v44
v_bfe_u32 v44, v43, 4, 1
v_bfe_u32 v46, v43, 5, 1
v_lshl_or_b32 v44, v46, 16, v44
v_mul_u32_u24 v222, 0x3f80, v44
v_bfe_u32 v44, v43, 6, 1
v_bfe_u32 v46, v43, 7, 1
v_lshl_or_b32 v44, v46, 16, v44
v_mul_u32_u24 v223, 0x3f80, v44
s_mov_b32 s79, 130023424
v_lshrrev_b32 v43, v42, s79
v_bfe_u32 v44, v43, 0, 1
v_bfe_u32 v46, v43, 1, 1
v_lshl_or_b32 v44, v46, 16, v44
v_mul_u32_u24 v224, 0x3f80, v44
v_bfe_u32 v44, v43, 2, 1
v_bfe_u32 v46, v43, 3, 1
v_lshl_or_b32 v44, v46, 16, v44
v_mul_u32_u24 v225, 0x3f80, v44
v_bfe_u32 v44, v43, 4, 1
v_bfe_u32 v46, v43, 5, 1
v_lshl_or_b32 v44, v46, 16, v44
v_mul_u32_u24 v226, 0x3f80, v44
v_bfe_u32 v44, v43, 6, 1
v_bfe_u32 v46, v43, 7, 1
v_lshl_or_b32 v44, v46, 16, v44
v_mul_u32_u24 v227, 0x3f80, v44
s_waitcnt lgkmcnt(0)
s_load_dword s1, s[64:65], 0
s_mov_b64 s[4:5], s[46:47]
s_mov_b64 s[8:9], s[38:39]
buffer_load_ushort v16, v3, s[4:7], s72 offen
buffer_load_dword v4, v1, s[8:11], s71 offen
buffer_load_ushort v5, v2, s[8:11], s71 offen offset:256
s_mov_b64 s[12:13], s[40:41]
s_mov_b64 s[16:17], s[42:43]
s_mov_b64 s[20:21], s[44:45]
s_mov_b64 s[32:33], s[48:49]
buffer_load_dword v6, v1, s[12:15], s71 offen
buffer_load_ushort v7, v2, s[12:15], s71 offen offset:256
buffer_load_dword v8, v1, s[16:19], s71 offen
buffer_load_ushort v9, v2, s[16:19], s71 offen offset:256
buffer_load_dword v10, v1, s[20:23], s71 offen
buffer_load_ushort v11, v2, s[20:23], s71 offen offset:256
buffer_load_ushort v17, v3, s[32:35], s72 offen
s_mov_b32 s79, 266338304
v_lshrrev_b32 v43, v42, s79
v_bfe_u32 v44, v43, 0, 1
v_bfe_u32 v46, v43, 1, 1
v_lshl_or_b32 v44, v46, 16, v44
v_mul_u32_u24 v228, 0x3f80, v44
v_bfe_u32 v44, v43, 2, 1
v_bfe_u32 v46, v43, 3, 1
v_lshl_or_b32 v44, v46, 16, v44
v_mul_u32_u24 v229, 0x3f80, v44
v_bfe_u32 v44, v43, 4, 1
v_bfe_u32 v46, v43, 5, 1
v_lshl_or_b32 v44, v46, 16, v44
v_mul_u32_u24 v230, 0x3f80, v44
v_bfe_u32 v44, v43, 6, 1
v_bfe_u32 v46, v43, 7, 1
v_lshl_or_b32 v44, v46, 16, v44
v_mul_u32_u24 v231, 0x3f80, v44
s_mov_b32 s79, 535822336
v_lshrrev_b32 v43, v42, s79
v_bfe_u32 v44, v43, 0, 1
v_bfe_u32 v46, v43, 1, 1
v_lshl_or_b32 v44, v46, 16, v44
v_mul_u32_u24 v232, 0x3f80, v44
v_bfe_u32 v44, v43, 2, 1
v_bfe_u32 v46, v43, 3, 1
v_lshl_or_b32 v44, v46, 16, v44
v_mul_u32_u24 v233, 0x3f80, v44
v_bfe_u32 v44, v43, 4, 1
v_bfe_u32 v46, v43, 5, 1
v_lshl_or_b32 v44, v46, 16, v44
v_mul_u32_u24 v234, 0x3f80, v44
v_bfe_u32 v44, v43, 6, 1
v_bfe_u32 v46, v43, 7, 1
v_lshl_or_b32 v44, v46, 16, v44
v_mul_u32_u24 v235, 0x3f80, v44
s_mov_b32 s79, 805306368
v_lshrrev_b32 v43, v42, s79
v_bfe_u32 v44, v43, 0, 1
v_bfe_u32 v46, v43, 1, 1
v_lshl_or_b32 v44, v46, 16, v44
v_mul_u32_u24 v236, 0x3f80, v44
v_bfe_u32 v44, v43, 2, 1
v_bfe_u32 v46, v43, 3, 1
v_lshl_or_b32 v44, v46, 16, v44
v_mul_u32_u24 v237, 0x3f80, v44
v_bfe_u32 v44, v43, 4, 1
v_bfe_u32 v46, v43, 5, 1
v_lshl_or_b32 v44, v46, 16, v44
v_mul_u32_u24 v238, 0x3f80, v44
v_bfe_u32 v44, v43, 6, 1
v_bfe_u32 v46, v43, 7, 1
v_lshl_or_b32 v44, v46, 16, v44
v_mul_u32_u24 v239, 0x3f80, v44
s_add_u32 s79, s76, 5760
v_mul_u32_u24 v14, 208, v0
v_add_u32 v241, s79, v14
v_bfe_u32 v14, v0, 3, 1
v_lshrrev_b32 v15, 5, v0
v_lshlrev_b32 v14, 3, v14
v_lshl_add_u32 v14, v15, 1, v14
v_mul_u32_u24 v14, 208, v14
v_add_u32 v14, s79, v14
v_bfe_u32 v15, v0, 2, 1
v_and_b32 v43, 3, v0
v_bfe_u32 v44, v0, 4, 1
v_lshl_add_u32 v158, v15, 6, v14
v_lshl_add_u32 v158, v44, 5, v158
v_lshl_add_u32 v158, v43, 3, v158
v_lshlrev_b32 v46, 5, v15
v_lshl_add_u32 v46, v43, 3, v46
v_add_u32 v46, 128, v46
v_lshlrev_b32 v15, 3, v15
v_add_u32 v15, 192, v15
v_cmp_eq_u32 vcc, 1, v44
s_nop 1
v_cndmask_b32 v46, v46, v15, vcc
v_add_u32 v159, v14, v46
v_and_b32 v43, 1, v0
v_mul_u32_u24 v43, 1986, v43
v_add_u32 v43, v43, v41
v_lshlrev_b32 v44, 1, v45
v_sub_u32 v43, v43, v44
v_add_u32 v243, s78, v43
v_add_u32 v244, 1024, v243
v_mul_u32_u24 v43, 272, v45
v_add3_u32 v245, v43, v41, s76
v_lshl_add_u32 v43, v45, 4, v41
v_add_u32 v44, 624, v43
v_lshrrev_b32 v46, 7, v44
v_lshlrev_b32 v46, 4, v46
v_lshl_add_u32 v44, v44, 1, v46
v_add_u32 v246, s76, v44
v_add_u32 v44, 616, v43
v_lshrrev_b32 v46, 7, v44
v_lshlrev_b32 v46, 4, v46
v_lshl_add_u32 v44, v44, 1, v46
v_add_u32 v249, s76, v44
s_add_u32 s79, s76, 9856
v_mul_u32_u24 v43, 528, v45
v_lshl_add_u32 v43, v40, 4, v43
v_add_u32 v248, s79, v43
v_lshrrev_b32 v43, 3, v45
v_add_u32 v43, v43, v40
v_lshlrev_b32 v43, 4, v43
v_lshl_add_u32 v43, v45, 6, v43
v_add_u32 v250, s79, v43
v_and_b32 v41, 1, v40
v_lshrrev_b32 v42, 1, v40
v_lshlrev_b32 v247, 5, v45
v_lshl_add_u32 v247, v41, 9, v247
v_lshl_add_u32 v247, v42, 4, v247
s_bitcmp1_b32 s66, 0
s_mov_b32 s80, 268435456
s_mov_b32 s81, 571543825
s_cmov_b32 s80, 858989090
s_cmov_b32 s81, 1145324595
s_mov_b32 s82, 244595280
s_cmov_b32 s82, 2768916645
v_lshlrev_b32 v43, 2, v45
v_lshrrev_b64 v[46:47], v43, s[80:81]
v_and_b32 v46, 7, v46
v_lshlrev_b32 v43, 1, v45
v_lshrrev_b32 v43, v43, s82
v_and_b32 v43, 3, v43
s_lshr_b32 s79, s66, 1
s_lshr_b32 s80, s68, 4
s_add_u32 s80, s80, 10
s_sub_u32 s80, s80, s79
v_lshlrev_b32 v44, 1, v46
v_sub_u32 v44, s80, v44
v_subrev_u32 v47, 10, v44
v_min_u32 v44, v44, v47
v_lshrrev_b32 v44, 1, v44
v_mad_u32_u24 v44, v43, 6, v44
v_mad_u32_u24 v44, v46, 24, v44
s_mul_i32 s79, s79, 15360
s_add_u32 s79, s79, 81920
v_lshl_add_u32 v44, v44, 7, s79
s_mul_i32 s79, s66, 3072
s_add_u32 s79, s79, 6144
v_min_u32 v252, 39, v0
v_lshl_add_u32 v252, v252, 7, s79
v_cmp_gt_u32 vcc, 16, v0
s_nop 1
v_cndmask_b32 v252, v252, v44, vcc
v_lshlrev_b32 v255, 7, v0
v_lshrrev_b32 v43, 2, v0
v_mul_u32_u24 v253, 10368, v43
v_and_b32 v44, 3, v0
v_lshl_add_u32 v253, v44, 4, v253
v_mul_u32_u24 v240, 20480, v44
v_lshl_add_u32 v240, v43, 4, v240
s_mul_i32 s79, s66, 1088
s_add_u32 s79, s79, 1360
v_add_u32 v240, s79, v240
v_mov_b32 v254, 0
v_mov_b32 v64, 0
v_mov_b32 v65, 0
v_mov_b32 v66, 0
v_mov_b32 v67, 0
v_mov_b32 v68, 0
v_mov_b32 v69, 0
v_mov_b32 v70, 0
v_mov_b32 v71, 0
v_mov_b32 v72, 0
v_mov_b32 v73, 0
v_mov_b32 v74, 0
v_mov_b32 v75, 0
v_mov_b32 v76, 0
v_mov_b32 v77, 0
v_mov_b32 v78, 0
v_mov_b32 v79, 0
v_mov_b32 v80, 0
v_mov_b32 v81, 0
v_mov_b32 v82, 0
v_mov_b32 v83, 0
v_mov_b32 v84, 0
v_mov_b32 v85, 0
v_mov_b32 v86, 0
v_mov_b32 v87, 0
v_mov_b32 v88, 0
v_mov_b32 v89, 0
v_mov_b32 v90, 0
v_mov_b32 v91, 0
v_mov_b32 v92, 0
v_mov_b32 v93, 0
v_mov_b32 v94, 0
v_mov_b32 v95, 0
v_mov_b32 v96, 0
v_mov_b32 v97, 0
v_mov_b32 v98, 0
v_mov_b32 v99, 0
v_mov_b32 v100, 0
v_mov_b32 v101, 0
v_mov_b32 v102, 0
v_mov_b32 v103, 0
v_mov_b32 v104, 0
v_mov_b32 v105, 0
v_mov_b32 v106, 0
v_mov_b32 v107, 0
v_mov_b32 v108, 0
v_mov_b32 v109, 0
v_mov_b32 v110, 0
v_mov_b32 v111, 0
v_mov_b32 v112, 0
v_mov_b32 v113, 0
v_mov_b32 v114, 0
v_mov_b32 v115, 0
v_mov_b32 v116, 0
v_mov_b32 v117, 0
v_mov_b32 v118, 0
v_mov_b32 v119, 0
v_mov_b32 v120, 0
v_mov_b32 v121, 0
v_mov_b32 v122, 0
v_mov_b32 v123, 0
v_mov_b32 v124, 0
v_mov_b32 v125, 0
v_mov_b32 v126, 0
v_mov_b32 v127, 0
s_mov_b32 s24, s64
s_mov_b32 s25, s65
s_mov_b32 s26, 114688
s_mov_b32 s27, 0x20000
v_mov_b32 v48, 0
v_mov_b32 v49, 0
v_mov_b32 v50, 0
v_mov_b32 v51, 0
v_mov_b32 v52, 0
v_mov_b32 v53, 0
v_mov_b32 v54, 0
v_mov_b32 v55, 0
v_mov_b32 v56, 0
v_mov_b32 v57, 0
v_mov_b32 v58, 0
v_mov_b32 v59, 0
v_mov_b32 v60, 0
v_mov_b32 v61, 0
v_mov_b32 v62, 0
v_mov_b32 v63, 0
s_waitcnt vmcnt(0) lgkmcnt(0)
v_lshlrev_b32 v16, 16, v16
v_mul_f32 v16, 0x3fb8aa3b, v16
v_exp_f32 v16, v16
v_lshlrev_b32 v20, 16, v4
v_and_b32 v22, 0xffff0000, v4
v_lshlrev_b32 v24, 16, v5
v_cvt_pk_bf16_f32 v16, v16, v16
v_lshlrev_b32 v16, 16, v16
v_mul_f32 v20, 0x3fb8aa3b, v20
v_mul_f32 v22, 0x3fb8aa3b, v22
v_mul_f32 v24, 0x3fb8aa3b, v24
v_exp_f32 v20, v20
v_exp_f32 v22, v22
v_exp_f32 v24, v24
v_lshlrev_b32 v21, 16, v6
v_and_b32 v23, 0xffff0000, v6
v_lshlrev_b32 v25, 16, v7
v_cvt_pk_bf16_f32 v4, v20, v22
v_cvt_pk_bf16_f32 v5, v24, v24
v_lshlrev_b32 v20, 16, v4
v_and_b32 v22, 0xffff0000, v4
v_lshlrev_b32 v24, 16, v5
v_lshlrev_b32 v26, 16, v8
v_and_b32 v28, 0xffff0000, v8
v_lshlrev_b32 v30, 16, v9
v_lshlrev_b32 v27, 16, v10
v_and_b32 v29, 0xffff0000, v10
v_lshlrev_b32 v31, 16, v11
v_add_f32 v18, v16, v16
v_lshlrev_b32 v242, 16, v17
v_mul_f32 v20, v16, v20
v_mul_f32 v21, v16, v21
v_mul_f32 v22, v16, v22
v_mul_f32 v23, v16, v23
v_mul_f32 v24, v16, v24
v_mul_f32 v25, v16, v25
v_mul_f32 v26, v18, v26
v_mul_f32 v27, v18, v27
v_mul_f32 v28, v18, v28
v_mul_f32 v29, v18, v29
v_mul_f32 v30, v18, v30
v_mul_f32 v31, v18, v31
v_mul_f32 v20, 0xbfb8aa3b, v20
v_mul_f32 v21, 0x3e22f983, v21
v_mul_f32 v22, 0xbfb8aa3b, v22
v_mul_f32 v23, 0x3e22f983, v23
v_mul_f32 v24, 0xbfb8aa3b, v24
v_mul_f32 v25, 0x3e22f983, v25
v_exp_f32 v4, v20
v_fract_f32 v5, v21
v_mul_f32 v6, 0x43800000, v20
v_mul_f32 v7, 0x43800000, v21
v_cos_f32 v8, v5
v_sin_f32 v9, v5
v_fract_f32 v7, v7
v_exp_f32 v6, v6
v_cos_f32 v10, v7
v_sin_f32 v11, v7
v_mul_f32 v32, v4, v8
v_mul_f32 v33, v4, v9
v_mul_f32 v34, v6, v10
v_mul_f32 v35, v6, v11
s_mul_i32 s1, s1, 0x9e3779b1
s_add_u32 s1, s1, 0x7f4a7c15
s_or_b32 s1, s1, 1
s_add_u32 s4, s64, 16777216
s_addc_u32 s5, s65, 0
s_mov_b32 s6, 2654208
s_mov_b32 s7, 0x20000
s_add_u32 s32, s64, 8388608
s_addc_u32 s33, s65, 0
s_mov_b32 s34, 2703360
s_mov_b32 s35, 0x20000
s_add_u32 s8, s64, 12582912
s_addc_u32 s9, s65, 0
s_mov_b32 s10, 1966080
s_mov_b32 s11, 0x20000
s_mul_i32 s72, s66, 663552
s_lshl_b32 s73, s68, 6
s_add_u32 s72, s72, s73
s_setprio 1
v_mov_b32 v19, 0
s_mov_b32 s77, 3
v_mul_f32 v42, v33, v33
v_mul_f32 v138, v27, v33
v_mul_f32 v43, v33, v32
v_mul_f32 v139, v27, v32
v_fma_f32 v37, v32, v33, v43
v_fma_f32 v135, v26, v33, v139
v_fma_f32 v36, v32, v32, -v42
v_fma_f32 v134, v26, v32, -v138
v_mul_f32 v42, v37, v37
v_cvt_pk_bf16_f32 v146, v26, v134
v_mul_f32 v43, v37, v36
v_cvt_pk_bf16_f32 v150, v27, v135
v_fma_f32 v39, v36, v37, v43
v_mul_f32 v138, v135, v33
v_fma_f32 v38, v36, v36, -v42
v_mul_f32 v139, v135, v32
v_mul_f32 v42, v39, v39
v_fma_f32 v137, v134, v33, v139
v_mul_f32 v43, v39, v38
v_fma_f32 v136, v134, v32, -v138
v_fma_f32 v41, -v38, v39, -v43
v_mul_f32 v138, v137, v33
v_fma_f32 v40, v38, v38, -v42
v_mul_f32 v139, v137, v32
v_cvt_pk_bf16_f32 v200, 1.0, v40
v_fma_f32 v135, v136, v33, v139
v_cvt_pk_bf16_f32 v204, 0, v41
v_fma_f32 v134, v136, v32, -v138
v_mul_f32 v132, v41, v41
v_mul_f32 v133, v41, v40
v_cvt_pk_bf16_f32 v147, v136, v134
v_fma_f32 v129, v40, v41, v133
v_fma_f32 v128, v40, v40, -v132
v_cvt_pk_bf16_f32 v151, v137, v135
v_mul_f32 v132, v129, v41
v_mul_f32 v133, v129, v40
v_mul_f32 v138, v135, v33
v_fma_f32 v131, v128, v41, v133
v_mul_f32 v139, v135, v32
v_fma_f32 v130, v128, v40, -v132
v_cvt_pk_bf16_f32 v201, v128, v130
v_fma_f32 v137, v134, v33, v139
v_cvt_pk_bf16_f32 v205, v129, v131
v_mul_f32 v132, v131, v41
v_fma_f32 v136, v134, v32, -v138
v_mul_f32 v133, v131, v40
v_fma_f32 v129, v130, v41, v133
v_mul_f32 v138, v137, v33
v_fma_f32 v128, v130, v40, -v132
v_mul_f32 v139, v137, v32
v_mul_f32 v132, v129, v41
v_mul_f32 v133, v129, v40
v_fma_f32 v135, v136, v33, v139
v_fma_f32 v131, v128, v41, v133
v_fma_f32 v130, v128, v40, -v132
v_fma_f32 v134, v136, v32, -v138
v_cvt_pk_bf16_f32 v202, v128, v130
v_cvt_pk_bf16_f32 v206, v129, v131
v_cvt_pk_bf16_f32 v148, v136, v134
v_mul_f32 v132, v131, v41
v_cvt_pk_bf16_f32 v152, v137, v135
v_mul_f32 v133, v131, v40
v_fma_f32 v129, v130, v41, v133
v_mul_f32 v138, v135, v33
v_fma_f32 v128, v130, v40, -v132
v_mul_f32 v132, v129, v41
v_mul_f32 v139, v135, v32
v_mul_f32 v133, v129, v40
v_fma_f32 v131, v128, v41, v133
v_fma_f32 v137, v134, v33, v139
v_fma_f32 v130, v128, v40, -v132
v_fma_f32 v136, v134, v32, -v138
v_cvt_pk_bf16_f32 v203, v128, v130
v_cvt_pk_bf16_f32 v207, v129, v131
v_mul_f32 v138, v137, v33
v_mul_f32 v139, v137, v32
v_mul_f32 v132, v131, v41
ds_write_b128 v241, v[200:203] offset:0
v_mul_f32 v133, v131, v40
v_fma_f32 v135, v136, v33, v139
v_fma_f32 v129, v130, v41, v133
v_fma_f32 v134, v136, v32, -v138
v_fma_f32 v128, v130, v40, -v132
v_mul_f32 v132, v129, v41
v_cvt_pk_bf16_f32 v149, v136, v134
v_mul_f32 v133, v129, v40
ds_write_b128 v241, v[204:207] offset:64
v_fma_f32 v131, v128, v41, v133
v_cvt_pk_bf16_f32 v153, v137, v135
v_fma_f32 v130, v128, v40, -v132
v_cvt_pk_bf16_f32 v208, v128, v130
v_cvt_pk_bf16_f32 v212, v129, v131
v_mul_f32 v132, v131, v41
v_mul_f32 v133, v131, v40
v_mul_f32 v144, v27, v35
ds_write_b128 v241, v[146:149] offset:128
v_fma_f32 v129, v130, v41, v133
v_fma_f32 v128, v130, v40, -v132
v_mul_f32 v145, v27, v34
v_mul_f32 v132, v129, v41
v_mul_f32 v133, v129, v40
v_fma_f32 v141, v26, v35, v145
v_fma_f32 v131, v128, v41, v133
v_fma_f32 v140, v26, v34, -v144
ds_write_b128 v241, v[150:153] offset:160
v_fma_f32 v130, v128, v40, -v132
v_cvt_pk_bf16_f32 v209, v128, v130
v_mul_f32 v138, v141, v37
v_cvt_pk_bf16_f32 v213, v129, v131
v_mul_f32 v132, v131, v41
v_mul_f32 v139, v141, v36
v_mul_f32 v133, v131, v40
v_fma_f32 v129, v130, v41, v133
v_fma_f32 v135, v140, v37, v139
v_fma_f32 v128, v130, v40, -v132
v_mul_f32 v132, v129, v41
v_fma_f32 v134, v140, v36, -v138
v_mul_f32 v133, v129, v40
v_cvt_pk_bf16_f32 v154, v140, v134
v_fma_f32 v131, v128, v41, v133
v_fma_f32 v130, v128, v40, -v132
v_cvt_pk_bf16_f32 v156, v141, v135
v_cvt_pk_bf16_f32 v210, v128, v130
v_cvt_pk_bf16_f32 v214, v129, v131
v_mul_f32 v138, v135, v37
v_mul_f32 v132, v131, v41
v_mul_f32 v133, v131, v40
v_mul_f32 v139, v135, v36
v_fma_f32 v129, v130, v41, v133
v_fma_f32 v137, v134, v37, v139
v_fma_f32 v128, v130, v40, -v132
v_mul_f32 v132, v129, v41
v_fma_f32 v136, v134, v36, -v138
v_mul_f32 v133, v129, v40
v_fma_f32 v131, v128, v41, v133
v_mul_f32 v138, v137, v37
v_fma_f32 v130, v128, v40, -v132
v_cvt_pk_bf16_f32 v211, v128, v130
v_mul_f32 v139, v137, v36
v_cvt_pk_bf16_f32 v215, v129, v131
v_fma_f32 v135, v136, v37, v139
v_fma_f32 v134, v136, v36, -v138
v_mul_f32 v132, v131, v41
ds_write_b128 v241, v[208:211] offset:16
v_mul_f32 v133, v131, v40
v_cvt_pk_bf16_f32 v155, v136, v134
v_fma_f32 v129, v130, v41, v133
v_fma_f32 v128, v130, v40, -v132
v_cvt_pk_bf16_f32 v157, v137, v135
v_mul_f32 v132, v129, v41
v_mul_f32 v133, v129, v40
v_fma_f32 v131, v128, v41, v133
ds_write_b128 v241, v[212:215] offset:80
v_mul_f32 v144, v141, v35
v_fma_f32 v130, v128, v40, -v132
v_cvt_pk_bf16_f32 v200, v128, v130
v_mul_f32 v145, v141, v34
v_cvt_pk_bf16_f32 v204, v129, v131
v_mul_f32 v132, v131, v41
v_fma_f32 v143, v140, v35, v145
v_mul_f32 v133, v131, v40
ds_write_b128 v241, v[154:157] offset:192
v_fma_f32 v142, v140, v34, -v144
v_fma_f32 v129, v130, v41, v133
v_fma_f32 v128, v130, v40, -v132
v_mul_f32 v138, v143, v39
v_mul_f32 v132, v129, v41
v_mul_f32 v133, v129, v40
v_mul_f32 v139, v143, v38
v_fma_f32 v131, v128, v41, v133
v_fma_f32 v130, v128, v40, -v132
v_fma_f32 v135, v142, v39, v139
v_cvt_pk_bf16_f32 v201, v128, v130
v_fma_f32 v134, v142, v38, -v138
v_cvt_pk_bf16_f32 v205, v129, v131
v_mul_f32 v132, v131, v41
v_cvt_pk_bf16_f32 v146, v142, v134
v_mul_f32 v133, v131, v40
v_fma_f32 v129, v130, v41, v133
v_cvt_pk_bf16_f32 v150, v143, v135
v_fma_f32 v128, v130, v40, -v132
v_mul_f32 v132, v129, v41
v_mul_f32 v144, v143, v35
v_mul_f32 v133, v129, v40
v_mul_f32 v145, v143, v34
v_fma_f32 v131, v128, v41, v133
v_fma_f32 v130, v128, v40, -v132
v_fma_f32 v141, v142, v35, v145
v_cvt_pk_bf16_f32 v202, v128, v130
v_cvt_pk_bf16_f32 v206, v129, v131
v_fma_f32 v140, v142, v34, -v144
v_mul_f32 v132, v131, v41
v_mul_f32 v133, v131, v40
v_mul_f32 v138, v141, v39
v_fma_f32 v129, v130, v41, v133
v_fma_f32 v128, v130, v40, -v132
v_mul_f32 v139, v141, v38
v_mul_f32 v132, v129, v41
v_fma_f32 v135, v140, v39, v139
v_mul_f32 v133, v129, v40
v_fma_f32 v131, v128, v41, v133
v_fma_f32 v134, v140, v38, -v138
v_fma_f32 v130, v128, v40, -v132
v_cvt_pk_bf16_f32 v203, v128, v130
v_cvt_pk_bf16_f32 v148, v140, v134
v_cvt_pk_bf16_f32 v207, v129, v131
v_cvt_pk_bf16_f32 v152, v141, v135
v_mul_f32 v144, v141, v35
ds_write_b128 v241, v[200:203] offset:32
v_mul_f32 v132, v131, v41
v_mul_f32 v133, v131, v40
v_mul_f32 v145, v141, v34
v_fma_f32 v129, v130, v41, v133
v_fma_f32 v128, v130, v40, -v132
v_fma_f32 v143, v140, v35, v145
v_mul_f32 v132, v129, v41
v_mul_f32 v133, v129, v40
ds_write_b128 v241, v[204:207] offset:96
v_fma_f32 v142, v140, v34, -v144
v_fma_f32 v131, v128, v41, v133
v_mul_f32 v144, v143, v35
v_fma_f32 v130, v128, v40, -v132
v_cvt_pk_bf16_f32 v208, v128, v130
v_mul_f32 v145, v143, v34
v_cvt_pk_bf16_f32 v212, v129, v131
v_mul_f32 v132, v131, v41
v_fma_f32 v141, v142, v35, v145
v_mul_f32 v133, v131, v40
v_fma_f32 v129, v130, v41, v133
v_fma_f32 v140, v142, v34, -v144
v_fma_f32 v128, v130, v40, -v132
v_cvt_pk_bf16_f32 v147, v142, v140
v_mul_f32 v132, v129, v41
v_mul_f32 v133, v129, v40
v_cvt_pk_bf16_f32 v151, v143, v141
v_fma_f32 v131, v128, v41, v133
v_fma_f32 v130, v128, v40, -v132
v_mul_f32 v144, v141, v35
v_cvt_pk_bf16_f32 v209, v128, v130
v_cvt_pk_bf16_f32 v213, v129, v131
v_mul_f32 v145, v141, v34
v_mul_f32 v132, v131, v41
v_fma_f32 v143, v140, v35, v145
v_mul_f32 v133, v131, v40
v_fma_f32 v129, v130, v41, v133
v_fma_f32 v142, v140, v34, -v144
v_fma_f32 v128, v130, v40, -v132
v_mul_f32 v132, v129, v41
v_mul_f32 v144, v143, v35
v_mul_f32 v133, v129, v40
v_fma_f32 v131, v128, v41, v133
v_mul_f32 v145, v143, v34
v_fma_f32 v130, v128, v40, -v132
v_fma_f32 v141, v142, v35, v145
v_cvt_pk_bf16_f32 v210, v128, v130
v_cvt_pk_bf16_f32 v214, v129, v131
v_fma_f32 v140, v142, v34, -v144
v_mul_f32 v132, v131, v41
v_mul_f32 v133, v131, v40
v_cvt_pk_bf16_f32 v149, v142, v140
v_fma_f32 v129, v130, v41, v133
v_fma_f32 v128, v130, v40, -v132
v_cvt_pk_bf16_f32 v153, v143, v141
v_mul_f32 v132, v129, v41
v_mul_f32 v133, v129, v40
v_fma_f32 v131, v128, v41, v133
ds_write_b128 v241, v[146:149] offset:144
v_fma_f32 v130, v128, v40, -v132
v_cvt_pk_bf16_f32 v211, v128, v130
v_fma_f32 v19, v140, v34, v19
v_cvt_pk_bf16_f32 v215, v129, v131
v_fma_f32 v19, -v141, v35, v19
ds_write_b128 v241, v[150:153] offset:176
ds_write_b128 v241, v[208:211] offset:48
ds_write_b128 v241, v[212:215] offset:112
v_mov_b32 v20, v22
v_mov_b32 v26, v28
v_mov_b32 v21, v23
v_mov_b32 v27, v29
v_mov_b32 v22, v24
v_mov_b32 v28, v30
v_mov_b32 v23, v25
v_mov_b32 v29, v31
ds_read_b64_tr_b16 v[64:65], v159 offset:0
ds_read_b64_tr_b16 v[96:97], v158 offset:0
v_exp_f32 v4, v20
ds_read_b64_tr_b16 v[66:67], v159 offset:208
ds_read_b64_tr_b16 v[98:99], v158 offset:208
v_fract_f32 v5, v21
ds_read_b64_tr_b16 v[68:69], v159 offset:832
ds_read_b64_tr_b16 v[100:101], v158 offset:832
v_mul_f32 v6, 0x43800000, v20
ds_read_b64_tr_b16 v[70:71], v159 offset:1040
ds_read_b64_tr_b16 v[102:103], v158 offset:1040
v_mul_f32 v7, 0x43800000, v21
ds_read_b64_tr_b16 v[72:73], v159 offset:3328
ds_read_b64_tr_b16 v[104:105], v158 offset:3328
v_cos_f32 v8, v5
ds_read_b64_tr_b16 v[74:75], v159 offset:3536
ds_read_b64_tr_b16 v[106:107], v158 offset:3536
v_sin_f32 v9, v5
ds_read_b64_tr_b16 v[76:77], v159 offset:4160
ds_read_b64_tr_b16 v[108:109], v158 offset:4160
v_fract_f32 v7, v7
ds_read_b64_tr_b16 v[78:79], v159 offset:4368
ds_read_b64_tr_b16 v[110:111], v158 offset:4368
v_exp_f32 v6, v6
ds_read_b64_tr_b16 v[80:81], v159 offset:6656
ds_read_b64_tr_b16 v[112:113], v158 offset:6656
v_cos_f32 v10, v7
ds_read_b64_tr_b16 v[82:83], v159 offset:6864
ds_read_b64_tr_b16 v[114:115], v158 offset:6864
v_sin_f32 v11, v7
ds_read_b64_tr_b16 v[84:85], v159 offset:7488
ds_read_b64_tr_b16 v[116:117], v158 offset:7488
v_mul_f32 v32, v4, v8
ds_read_b64_tr_b16 v[86:87], v159 offset:7696
ds_read_b64_tr_b16 v[118:119], v158 offset:7696
v_mul_f32 v33, v4, v9
ds_read_b64_tr_b16 v[88:89], v159 offset:9984
ds_read_b64_tr_b16 v[120:121], v158 offset:9984
v_mul_f32 v34, v6, v10
ds_read_b64_tr_b16 v[90:91], v159 offset:10192
ds_read_b64_tr_b16 v[122:123], v158 offset:10192
v_mul_f32 v35, v6, v11
ds_read_b64_tr_b16 v[92:93], v159 offset:10816
ds_read_b64_tr_b16 v[124:125], v158 offset:10816
ds_read_b64_tr_b16 v[94:95], v159 offset:11024
ds_read_b64_tr_b16 v[126:127], v158 offset:11024
s_mov_b32 s77, 2
L_kgen_24:
v_mul_f32 v42, v33, v33
v_mul_f32 v138, v27, v33
v_mul_f32 v43, v33, v32
v_mul_f32 v139, v27, v32
v_fma_f32 v37, v32, v33, v43
v_fma_f32 v135, v26, v33, v139
v_fma_f32 v36, v32, v32, -v42
v_fma_f32 v134, v26, v32, -v138
v_mul_f32 v42, v37, v37
v_cvt_pk_bf16_f32 v146, v26, v134
v_mul_f32 v43, v37, v36
v_cvt_pk_bf16_f32 v150, v27, v135
v_fma_f32 v39, v36, v37, v43
v_mul_f32 v138, v135, v33
v_fma_f32 v38, v36, v36, -v42
v_mul_f32 v139, v135, v32
v_mul_f32 v42, v39, v39
v_fma_f32 v137, v134, v33, v139
v_mul_f32 v43, v39, v38
v_fma_f32 v136, v134, v32, -v138
v_fma_f32 v41, -v38, v39, -v43
v_mul_f32 v138, v137, v33
v_fma_f32 v40, v38, v38, -v42
v_mul_f32 v139, v137, v32
v_cvt_pk_bf16_f32 v200, 1.0, v40
v_fma_f32 v135, v136, v33, v139
v_cvt_pk_bf16_f32 v204, 0, v41
v_fma_f32 v134, v136, v32, -v138
v_mul_f32 v132, v41, v41
v_mul_f32 v133, v41, v40
v_cvt_pk_bf16_f32 v147, v136, v134
v_fma_f32 v129, v40, v41, v133
v_fma_f32 v128, v40, v40, -v132
v_cvt_pk_bf16_f32 v151, v137, v135
v_mul_f32 v132, v129, v41
v_mul_f32 v133, v129, v40
v_mul_f32 v138, v135, v33
v_fma_f32 v131, v128, v41, v133
v_mul_f32 v139, v135, v32
v_fma_f32 v130, v128, v40, -v132
s_waitcnt lgkmcnt(0)
v_mfma_f32_32x32x16_bf16 v[48:63], v[64:67], v[96:99], v[48:63]
v_cvt_pk_bf16_f32 v201, v128, v130
v_fma_f32 v137, v134, v33, v139
v_cvt_pk_bf16_f32 v205, v129, v131
v_mul_f32 v132, v131, v41
v_fma_f32 v136, v134, v32, -v138
v_mul_f32 v133, v131, v40
v_fma_f32 v129, v130, v41, v133
v_mul_f32 v138, v137, v33
v_fma_f32 v128, v130, v40, -v132
v_mul_f32 v139, v137, v32
v_mul_f32 v132, v129, v41
v_mul_f32 v133, v129, v40
v_fma_f32 v135, v136, v33, v139
v_fma_f32 v131, v128, v41, v133
v_mfma_f32_32x32x16_bf16 v[48:63], v[68:71], v[100:103], v[48:63]
v_fma_f32 v130, v128, v40, -v132
v_fma_f32 v134, v136, v32, -v138
v_cvt_pk_bf16_f32 v202, v128, v130
v_cvt_pk_bf16_f32 v206, v129, v131
v_cvt_pk_bf16_f32 v148, v136, v134
v_mul_f32 v132, v131, v41
v_cvt_pk_bf16_f32 v152, v137, v135
v_mul_f32 v133, v131, v40
v_fma_f32 v129, v130, v41, v133
v_mul_f32 v138, v135, v33
v_fma_f32 v128, v130, v40, -v132
v_mul_f32 v132, v129, v41
v_mul_f32 v139, v135, v32
v_mul_f32 v133, v129, v40
v_mfma_f32_32x32x16_bf16 v[48:63], v[72:75], v[104:107], v[48:63]
v_fma_f32 v131, v128, v41, v133
v_fma_f32 v137, v134, v33, v139
v_fma_f32 v130, v128, v40, -v132
v_fma_f32 v136, v134, v32, -v138
v_cvt_pk_bf16_f32 v203, v128, v130
v_cvt_pk_bf16_f32 v207, v129, v131
v_mul_f32 v138, v137, v33
v_mul_f32 v139, v137, v32
v_mul_f32 v132, v131, v41
ds_write_b128 v241, v[200:203] offset:0
v_mul_f32 v133, v131, v40
v_fma_f32 v135, v136, v33, v139
v_fma_f32 v129, v130, v41, v133
v_fma_f32 v134, v136, v32, -v138
v_mfma_f32_32x32x16_bf16 v[48:63], v[76:79], v[108:111], v[48:63]
v_fma_f32 v128, v130, v40, -v132
v_mul_f32 v132, v129, v41
v_cvt_pk_bf16_f32 v149, v136, v134
v_mul_f32 v133, v129, v40
ds_write_b128 v241, v[204:207] offset:64
v_fma_f32 v131, v128, v41, v133
v_cvt_pk_bf16_f32 v153, v137, v135
v_fma_f32 v130, v128, v40, -v132
v_cvt_pk_bf16_f32 v208, v128, v130
v_cvt_pk_bf16_f32 v212, v129, v131
v_mul_f32 v132, v131, v41
v_mul_f32 v133, v131, v40
v_mul_f32 v144, v27, v35
ds_write_b128 v241, v[146:149] offset:128
v_mfma_f32_32x32x16_bf16 v[48:63], v[80:83], v[112:115], v[48:63]
v_fma_f32 v129, v130, v41, v133
v_fma_f32 v128, v130, v40, -v132
v_mul_f32 v145, v27, v34
v_mul_f32 v132, v129, v41
v_mul_f32 v133, v129, v40
v_fma_f32 v141, v26, v35, v145
v_fma_f32 v131, v128, v41, v133
v_fma_f32 v140, v26, v34, -v144
ds_write_b128 v241, v[150:153] offset:160
v_fma_f32 v130, v128, v40, -v132
v_cvt_pk_bf16_f32 v209, v128, v130
v_mul_f32 v138, v141, v37
v_cvt_pk_bf16_f32 v213, v129, v131
v_mul_f32 v132, v131, v41
v_mfma_f32_32x32x16_bf16 v[48:63], v[84:87], v[116:119], v[48:63]
v_mul_f32 v139, v141, v36
v_mul_f32 v133, v131, v40
v_fma_f32 v129, v130, v41, v133
v_fma_f32 v135, v140, v37, v139
v_fma_f32 v128, v130, v40, -v132
v_mul_f32 v132, v129, v41
v_fma_f32 v134, v140, v36, -v138
v_mul_f32 v133, v129, v40
v_cvt_pk_bf16_f32 v154, v140, v134
v_fma_f32 v131, v128, v41, v133
v_fma_f32 v130, v128, v40, -v132
v_cvt_pk_bf16_f32 v156, v141, v135
v_cvt_pk_bf16_f32 v210, v128, v130
v_cvt_pk_bf16_f32 v214, v129, v131
v_mfma_f32_32x32x16_bf16 v[48:63], v[88:91], v[120:123], v[48:63]
v_mul_f32 v138, v135, v37
v_mul_f32 v132, v131, v41
v_mul_f32 v133, v131, v40
v_mul_f32 v139, v135, v36
v_fma_f32 v129, v130, v41, v133
v_fma_f32 v137, v134, v37, v139
v_fma_f32 v128, v130, v40, -v132
v_mul_f32 v132, v129, v41
v_fma_f32 v136, v134, v36, -v138
v_mul_f32 v133, v129, v40
v_fma_f32 v131, v128, v41, v133
v_mul_f32 v138, v137, v37
v_fma_f32 v130, v128, v40, -v132
v_cvt_pk_bf16_f32 v211, v128, v130
v_mfma_f32_32x32x16_bf16 v[48:63], v[92:95], v[124:127], v[48:63]
v_mul_f32 v139, v137, v36
v_cvt_pk_bf16_f32 v215, v129, v131
v_fma_f32 v135, v136, v37, v139
v_fma_f32 v134, v136, v36, -v138
v_mul_f32 v132, v131, v41
ds_write_b128 v241, v[208:211] offset:16
v_mul_f32 v133, v131, v40
v_cvt_pk_bf16_f32 v155, v136, v134
v_fma_f32 v129, v130, v41, v133
v_fma_f32 v128, v130, v40, -v132
v_cvt_pk_bf16_f32 v157, v137, v135
v_mul_f32 v132, v129, v41
v_mul_f32 v133, v129, v40
v_fma_f32 v131, v128, v41, v133
ds_write_b128 v241, v[212:215] offset:80
v_mul_f32 v144, v141, v35
v_fma_f32 v130, v128, v40, -v132
v_cvt_pk_bf16_f32 v200, v128, v130
v_mul_f32 v145, v141, v34
v_cvt_pk_bf16_f32 v204, v129, v131
v_mul_f32 v132, v131, v41
v_fma_f32 v143, v140, v35, v145
v_mul_f32 v133, v131, v40
ds_write_b128 v241, v[154:157] offset:192
v_fma_f32 v142, v140, v34, -v144
v_fma_f32 v129, v130, v41, v133
v_fma_f32 v128, v130, v40, -v132
s_cmp_lg_u32 s77, 1
s_cbranch_scc1 L_nf_25
buffer_load_dword v196, v252, s[24:27], 0 offen sc1
L_nf_25:
v_mul_f32 v138, v143, v39
v_mul_f32 v132, v129, v41
v_mul_f32 v133, v129, v40
v_mul_f32 v139, v143, v38
v_fma_f32 v131, v128, v41, v133
v_fma_f32 v130, v128, v40, -v132
v_fma_f32 v135, v142, v39, v139
v_cvt_pk_bf16_f32 v201, v128, v130
v_fma_f32 v134, v142, v38, -v138
v_cvt_pk_bf16_f32 v205, v129, v131
v_mul_f32 v132, v131, v41
v_cvt_pk_bf16_f32 v146, v142, v134
v_mul_f32 v133, v131, v40
v_fma_f32 v129, v130, v41, v133
v_cvt_pk_bf16_f32 v150, v143, v135
v_fma_f32 v128, v130, v40, -v132
v_mul_f32 v132, v129, v41
v_mul_f32 v144, v143, v35
v_mul_f32 v133, v129, v40
v_mul_f32 v145, v143, v34
v_fma_f32 v131, v128, v41, v133
v_fma_f32 v130, v128, v40, -v132
v_fma_f32 v141, v142, v35, v145
v_cvt_pk_bf16_f32 v202, v128, v130
v_cvt_pk_bf16_f32 v206, v129, v131
v_fma_f32 v140, v142, v34, -v144
v_mul_f32 v132, v131, v41
v_mul_f32 v133, v131, v40
v_mul_f32 v138, v141, v39
v_fma_f32 v129, v130, v41, v133
v_fma_f32 v128, v130, v40, -v132
v_mul_f32 v139, v141, v38
v_mul_f32 v132, v129, v41
v_fma_f32 v135, v140, v39, v139
v_mul_f32 v133, v129, v40
v_fma_f32 v131, v128, v41, v133
v_fma_f32 v134, v140, v38, -v138
v_fma_f32 v130, v128, v40, -v132
v_cvt_pk_bf16_f32 v203, v128, v130
v_cvt_pk_bf16_f32 v148, v140, v134
v_cvt_pk_bf16_f32 v207, v129, v131
v_cvt_pk_bf16_f32 v152, v141, v135
v_mul_f32 v144, v141, v35
ds_write_b128 v241, v[200:203] offset:32
v_mul_f32 v132, v131, v41
v_mul_f32 v133, v131, v40
v_mul_f32 v145, v141, v34
v_fma_f32 v129, v130, v41, v133
v_fma_f32 v128, v130, v40, -v132
v_fma_f32 v143, v140, v35, v145
v_mul_f32 v132, v129, v41
v_mul_f32 v133, v129, v40
ds_write_b128 v241, v[204:207] offset:96
v_fma_f32 v142, v140, v34, -v144
v_fma_f32 v131, v128, v41, v133
v_mul_f32 v144, v143, v35
v_fma_f32 v130, v128, v40, -v132
v_cvt_pk_bf16_f32 v208, v128, v130
v_mul_f32 v145, v143, v34
v_cvt_pk_bf16_f32 v212, v129, v131
v_mul_f32 v132, v131, v41
v_fma_f32 v141, v142, v35, v145
v_mul_f32 v133, v131, v40
v_fma_f32 v129, v130, v41, v133
v_fma_f32 v140, v142, v34, -v144
v_fma_f32 v128, v130, v40, -v132
v_cvt_pk_bf16_f32 v147, v142, v140
v_mul_f32 v132, v129, v41
v_mul_f32 v133, v129, v40
v_cvt_pk_bf16_f32 v151, v143, v141
v_fma_f32 v131, v128, v41, v133
v_fma_f32 v130, v128, v40, -v132
v_mul_f32 v144, v141, v35
v_cvt_pk_bf16_f32 v209, v128, v130
v_cvt_pk_bf16_f32 v213, v129, v131
v_mul_f32 v145, v141, v34
v_mul_f32 v132, v131, v41
v_fma_f32 v143, v140, v35, v145
v_mul_f32 v133, v131, v40
v_fma_f32 v129, v130, v41, v133
v_fma_f32 v142, v140, v34, -v144
v_fma_f32 v128, v130, v40, -v132
v_mul_f32 v132, v129, v41
v_mul_f32 v144, v143, v35
v_mul_f32 v133, v129, v40
v_fma_f32 v131, v128, v41, v133
v_mul_f32 v145, v143, v34
v_fma_f32 v130, v128, v40, -v132
v_fma_f32 v141, v142, v35, v145
v_cvt_pk_bf16_f32 v210, v128, v130
v_cvt_pk_bf16_f32 v214, v129, v131
v_fma_f32 v140, v142, v34, -v144
v_mul_f32 v132, v131, v41
v_mul_f32 v133, v131, v40
v_cvt_pk_bf16_f32 v149, v142, v140
v_fma_f32 v129, v130, v41, v133
v_fma_f32 v128, v130, v40, -v132
v_cvt_pk_bf16_f32 v153, v143, v141
v_mul_f32 v132, v129, v41
v_mul_f32 v133, v129, v40
v_fma_f32 v131, v128, v41, v133
ds_write_b128 v241, v[146:149] offset:144
v_fma_f32 v130, v128, v40, -v132
v_cvt_pk_bf16_f32 v211, v128, v130
v_fma_f32 v19, v140, v34, v19
v_cvt_pk_bf16_f32 v215, v129, v131
v_fma_f32 v19, -v141, v35, v19
ds_write_b128 v241, v[150:153] offset:176
ds_write_b128 v241, v[208:211] offset:48
ds_write_b128 v241, v[212:215] offset:112
v_mov_b32 v20, v22
v_mov_b32 v26, v28
v_mov_b32 v21, v23
v_mov_b32 v27, v29
v_mov_b32 v22, v24
v_mov_b32 v28, v30
v_mov_b32 v23, v25
v_mov_b32 v29, v31
ds_read_b64_tr_b16 v[64:65], v159 offset:0
ds_read_b64_tr_b16 v[96:97], v158 offset:0
v_exp_f32 v4, v20
ds_read_b64_tr_b16 v[66:67], v159 offset:208
ds_read_b64_tr_b16 v[98:99], v158 offset:208
v_fract_f32 v5, v21
ds_read_b64_tr_b16 v[68:69], v159 offset:832
ds_read_b64_tr_b16 v[100:101], v158 offset:832
v_mul_f32 v6, 0x43800000, v20
ds_read_b64_tr_b16 v[70:71], v159 offset:1040
ds_read_b64_tr_b16 v[102:103], v158 offset:1040
v_mul_f32 v7, 0x43800000, v21
ds_read_b64_tr_b16 v[72:73], v159 offset:3328
ds_read_b64_tr_b16 v[104:105], v158 offset:3328
v_cos_f32 v8, v5
ds_read_b64_tr_b16 v[74:75], v159 offset:3536
ds_read_b64_tr_b16 v[106:107], v158 offset:3536
v_sin_f32 v9, v5
ds_read_b64_tr_b16 v[76:77], v159 offset:4160
ds_read_b64_tr_b16 v[108:109], v158 offset:4160
v_fract_f32 v7, v7
ds_read_b64_tr_b16 v[78:79], v159 offset:4368
ds_read_b64_tr_b16 v[110:111], v158 offset:4368
v_exp_f32 v6, v6
ds_read_b64_tr_b16 v[80:81], v159 offset:6656
ds_read_b64_tr_b16 v[112:113], v158 offset:6656
v_cos_f32 v10, v7
ds_read_b64_tr_b16 v[82:83], v159 offset:6864
ds_read_b64_tr_b16 v[114:115], v158 offset:6864
v_sin_f32 v11, v7
ds_read_b64_tr_b16 v[84:85], v159 offset:7488
ds_read_b64_tr_b16 v[116:117], v158 offset:7488
v_mul_f32 v32, v4, v8
ds_read_b64_tr_b16 v[86:87], v159 offset:7696
ds_read_b64_tr_b16 v[118:119], v158 offset:7696
v_mul_f32 v33, v4, v9
ds_read_b64_tr_b16 v[88:89], v159 offset:9984
ds_read_b64_tr_b16 v[120:121], v158 offset:9984
v_mul_f32 v34, v6, v10
ds_read_b64_tr_b16 v[90:91], v159 offset:10192
ds_read_b64_tr_b16 v[122:123], v158 offset:10192
v_mul_f32 v35, v6, v11
ds_read_b64_tr_b16 v[92:93], v159 offset:10816
ds_read_b64_tr_b16 v[124:125], v158 offset:10816
ds_read_b64_tr_b16 v[94:95], v159 offset:11024
ds_read_b64_tr_b16 v[126:127], v158 offset:11024
s_sub_u32 s77, s77, 1
s_cmp_lg_u32 s77, 0
s_cbranch_scc1 L_kgen_24
s_waitcnt vmcnt(0)
s_mov_b32 s73, 10791
v_cmp_ne_u32 vcc, s1, v196
s_cbranch_vccz L_pollok_27
L_poll_26:
buffer_load_dword v196, v252, s[24:27], 0 offen sc1
s_waitcnt vmcnt(0)
v_cmp_ne_u32 vcc, s1, v196
s_cbranch_vccz L_pollok_27
s_sleep 8
s_sub_u32 s73, s73, 1
s_cbranch_scc0 L_poll_26
L_pollok_27:
buffer_load_dwordx4 v[160:163], v253, s[4:7], s72 offen sc1
s_add_u32 s72, s72, 165888
buffer_load_dwordx4 v[164:167], v253, s[4:7], s72 offen sc1
s_add_u32 s72, s72, 165888
buffer_load_dwordx4 v[168:171], v253, s[4:7], s72 offen sc1
s_add_u32 s72, s72, 165888
buffer_load_dwordx4 v[172:175], v253, s[4:7], s72 offen sc1
s_waitcnt lgkmcnt(15)
v_mfma_f32_32x32x16_bf16 v[48:63], v[64:67], v[96:99], v[48:63]
v_add_f32_dpp v19, v19, v19 row_ror:8 row_mask:0xf bank_mask:0xf
v_lshlrev_b32 v4, 4, v0
v_add_u32 v5, s78, v4
v_add_f32_dpp v19, v19, v19 row_ror:4 row_mask:0xf bank_mask:0xf
v_add_u32 v4, s76, v4
v_mov_b32 v8, 0
v_add_f32_dpp v19, v19, v19 row_ror:2 row_mask:0xf bank_mask:0xf
v_mov_b32 v9, 0
s_waitcnt lgkmcnt(15)
v_mfma_f32_32x32x16_bf16 v[48:63], v[68:71], v[100:103], v[48:63]
v_mov_b32 v10, 0
v_add_f32_dpp v19, v19, v19 row_ror:1 row_mask:0xf bank_mask:0xf
v_mov_b32 v11, 0
ds_write_b128 v5, v[8:11]
v_add_f32_dpp v19, v19, v19 row_bcast:15 row_mask:0xa bank_mask:0xf
ds_write_b128 v5, v[8:11] offset:1024
s_nop 0
v_add_f32_dpp v19, v19, v19 row_bcast:31 row_mask:0xc bank_mask:0xf
ds_write_b128 v5, v[8:11] offset:2048
s_waitcnt lgkmcnt(15)
v_mfma_f32_32x32x16_bf16 v[48:63], v[72:75], v[104:107], v[48:63]
ds_write_b128 v5, v[8:11] offset:3072
ds_write_b128 v4, v[8:11]
s_mov_b64 exec, 0x1fffff
ds_write_b128 v4, v[8:11] offset:1024
s_mov_b64 exec, -1
v_readlane_b32 s75, v19, 63
v_and_b32 v4, 31, v0
v_lshrrev_b32 v5, 5, v0
s_waitcnt lgkmcnt(15)
v_mfma_f32_32x32x16_bf16 v[48:63], v[76:79], v[108:111], v[48:63]
v_lshlrev_b32 v6, 4, v4
v_sub_u32 v6, s78, v6
v_lshlrev_b32 v7, 3, v5
v_sub_u32 v7, v6, v7
v_add_u32 v12, 3068, v7
v_add_u32 v13, 2552, v6
v_and_b32 v14, 30, v0
v_sub_u32 v14, s78, v14
s_waitcnt lgkmcnt(15)
v_mfma_f32_32x32x16_bf16 v[48:63], v[80:83], v[112:115], v[48:63]
v_lshlrev_b32 v15, 5, v5
v_sub_u32 v14, v14, v15
v_sub_u32 v15, v14, v15
v_and_b32 v18, 1, v0
v_cmp_eq_u32 vcc, 1, v18
v_mov_b32 v18, 1474
v_mov_b32 v19, 1184
v_mov_b32 v20, 1762
s_waitcnt lgkmcnt(14)
v_mfma_f32_32x32x16_bf16 v[48:63], v[84:87], v[116:119], v[48:63]
v_mov_b32 v24, 1280
v_mov_b32 v25, 1376
v_mov_b32 v26, 1600
v_cndmask_b32 v18, v18, v24, vcc
v_cndmask_b32 v19, v19, v25, vcc
v_cndmask_b32 v20, v20, v26, vcc
v_add_u32 v18, v14, v18
v_add_u32 v19, v14, v19
s_waitcnt lgkmcnt(10)
v_mfma_f32_32x32x16_bf16 v[48:63], v[88:91], v[120:123], v[48:63]
v_add_u32 v20, v15, v20
v_add_u32 v21, 32, v20
s_add_u32 s72, s78, 1410
s_add_u32 s73, s78, 1824
v_mov_b32 v24, s72
v_mov_b32 v25, s73
v_cmp_eq_u32 vcc, 0, v0
s_nop 1
v_cndmask_b32 v18, v18, v24, vcc
s_waitcnt lgkmcnt(6)
v_mfma_f32_32x32x16_bf16 v[48:63], v[92:95], v[124:127], v[48:63]
v_cndmask_b32 v21, v21, v25, vcc
v_cndmask_b32 v22, v254, v242, vcc
v_cvt_pk_bf16_f32 v27, s75, s75
s_setprio 1
s_mul_i32 s78, s70, 4224
v_cmp_eq_u32 vcc, 0, v0
s_nop 5
v_add_f32 v48, v48, v22
v_cndmask_b32 v24, v52, v54, vcc
v_cvt_pk_bf16_f32 v64, v59, v58
v_cvt_pk_bf16_f32 v65, v58, v58
v_cvt_pk_bf16_f32 v66, v57, v56
v_cvt_pk_bf16_f32 v67, v56, v56
v_cvt_pk_bf16_f32 v68, v58, v57
v_cvt_pk_bf16_f32 v69, v52, v52
v_cvt_pk_bf16_f32 v70, v24, v53
v_cvt_pk_bf16_f32 v71, v54, v55
v_cvt_pk_bf16_f32 v72, v51, v50
v_cvt_pk_bf16_f32 v73, v49, v48
v_cvt_pk_bf16_f32 v74, v50, v49
s_mov_b32 exec_hi, 0
ds_write2_b32 v6, v64, v65 offset0:141 offset1:142
ds_write2_b32 v6, v66, v67 offset0:143 offset1:144
ds_write_b16 v6, v64 offset:2550
ds_write2_b32 v13, v65, v68 offset0:0 offset1:1
ds_write_b32 v6, v67 offset:2560
ds_write_b16 v6, v67 offset:2564
s_mov_b32 exec_lo, 1
ds_write2_b32 v6, v69, v69 offset0:15 offset1:16
ds_write_b16 v6, v69 offset:2046
ds_write_b32 v6, v69 offset:2048
ds_write_b16 v6, v69 offset:2052
s_mov_b32 exec_lo, 0
s_mov_b32 exec_hi, 1
ds_write_b16 v6, v27 offset:1666
ds_write_b16 v6, v27 offset:3652
s_mov_b64 exec, -1
ds_write_b16 v7, v72 offset:1082
ds_write_b32 v7, v74 offset:1084
ds_write_b16_d16_hi v7, v73 offset:1088
ds_write2_b32 v12, v72, v73 offset0:0 offset1:1
ds_write_b16 v18, v70 offset:0
ds_write_b16_d16_hi v19, v70 offset:0
ds_write_b16 v21, v71 offset:0
ds_write_b16_d16_hi v20, v71 offset:0
ds_write_b16 v18, v70 offset:1986
ds_write_b16_d16_hi v19, v70 offset:1986
ds_write_b16 v21, v71 offset:1986
ds_write_b16_d16_hi v20, v71 offset:1986
ds_read2_b32 v[130:131], v244 offset0:8 offset1:9
ds_read2_b32 v[132:133], v244 offset0:16 offset1:17
ds_read2_b32 v[134:135], v243 offset0:248 offset1:249
ds_read2_b32 v[136:137], v244 offset0:0 offset1:1
s_waitcnt vmcnt(0)
ds_write_b128 v240, v[160:163] offset:0
ds_write_b128 v240, v[164:167] offset:272
ds_write_b128 v240, v[168:171] offset:544
ds_write_b128 v240, v[172:175] offset:816
s_lshl_b32 s79, s68, 7
s_add_u32 s0, s79, 55296
s_waitcnt lgkmcnt(0)
s_barrier
ds_read_b64 v[112:113], v245 offset:1312
ds_read_b64 v[114:115], v245 offset:1360
ds_read_b64 v[116:117], v245 offset:1392
ds_read_b64 v[118:119], v245 offset:1424
ds_read_b64 v[120:121], v245 offset:1456
ds_read_b64 v[122:123], v245 offset:1488
ds_read_b64 v[124:125], v245 offset:1520
ds_read_b64 v[126:127], v245 offset:1552
ds_read_b64 v[128:129], v245 offset:1584
s_waitcnt lgkmcnt(7)
v_mfma_f32_16x16x32_bf16 v[16:19], v[130:133], v[112:115], 0
s_waitcnt lgkmcnt(6)
v_mfma_f32_16x16x32_bf16 v[20:23], v[130:133], v[114:117], 0
ds_read2_b32 v[138:139], v243 offset0:232 offset1:233
ds_read2_b32 v[140:141], v243 offset0:240 offset1:241
s_waitcnt lgkmcnt(7)
v_mfma_f32_16x16x32_bf16 v[24:27], v[130:133], v[116:119], 0
ds_read_b64 v[110:111], v245 offset:1280
s_waitcnt lgkmcnt(7)
v_mfma_f32_16x16x32_bf16 v[28:31], v[130:133], v[118:121], 0
ds_read_b64 v[108:109], v245 offset:1248
s_waitcnt lgkmcnt(7)
v_mfma_f32_16x16x32_bf16 v[32:35], v[130:133], v[120:123], 0
s_waitcnt lgkmcnt(6)
v_mfma_f32_16x16x32_bf16 v[36:39], v[130:133], v[122:125], 0
s_waitcnt lgkmcnt(5)
v_mfma_f32_16x16x32_bf16 v[40:43], v[130:133], v[124:127], 0
s_waitcnt lgkmcnt(4)
v_mfma_f32_16x16x32_bf16 v[44:47], v[130:133], v[126:129], 0
s_waitcnt lgkmcnt(15)
v_mfma_f32_16x16x32_bf16 v[44:47], v[134:137], v[122:125], v[44:47]
v_mfma_f32_16x16x32_bf16 v[40:43], v[134:137], v[120:123], v[40:43]
ds_read2_b32 v[130:131], v243 offset0:216 offset1:217
ds_read2_b32 v[132:133], v243 offset0:224 offset1:225
v_mfma_f32_16x16x32_bf16 v[36:39], v[134:137], v[118:121], v[36:39]
ds_read_b64 v[106:107], v245 offset:1216
v_mfma_f32_16x16x32_bf16 v[32:35], v[134:137], v[116:119], v[32:35]
ds_read_b64 v[104:105], v245 offset:1184
v_mfma_f32_16x16x32_bf16 v[28:31], v[134:137], v[114:117], v[28:31]
v_mfma_f32_16x16x32_bf16 v[24:27], v[134:137], v[112:115], v[24:27]
s_waitcnt lgkmcnt(5)
v_mfma_f32_16x16x32_bf16 v[20:23], v[134:137], v[110:113], v[20:23]
s_waitcnt lgkmcnt(4)
v_mfma_f32_16x16x32_bf16 v[16:19], v[134:137], v[108:111], v[16:19]
s_waitcnt lgkmcnt(6)
v_mfma_f32_16x16x32_bf16 v[44:47], v[138:141], v[118:121], v[44:47]
v_mfma_f32_16x16x32_bf16 v[40:43], v[138:141], v[116:119], v[40:43]
ds_read2_b32 v[134:135], v243 offset0:200 offset1:201
ds_read2_b32 v[136:137], v243 offset0:208 offset1:209
v_mfma_f32_16x16x32_bf16 v[36:39], v[138:141], v[114:117], v[36:39]
ds_read_b64 v[102:103], v245 offset:1152
v_mfma_f32_16x16x32_bf16 v[32:35], v[138:141], v[112:115], v[32:35]
ds_read_b64 v[100:101], v245 offset:1120
v_mfma_f32_16x16x32_bf16 v[28:31], v[138:141], v[110:113], v[28:31]
v_mfma_f32_16x16x32_bf16 v[24:27], v[138:141], v[108:111], v[24:27]
s_waitcnt lgkmcnt(5)
v_mfma_f32_16x16x32_bf16 v[20:23], v[138:141], v[106:109], v[20:23]
s_waitcnt lgkmcnt(4)
v_mfma_f32_16x16x32_bf16 v[16:19], v[138:141], v[104:107], v[16:19]
s_waitcnt lgkmcnt(6)
v_mfma_f32_16x16x32_bf16 v[44:47], v[130:133], v[114:117], v[44:47]
v_mfma_f32_16x16x32_bf16 v[40:43], v[130:133], v[112:115], v[40:43]
ds_read2_b32 v[138:139], v243 offset0:184 offset1:185
ds_read2_b32 v[140:141], v243 offset0:192 offset1:193
v_mfma_f32_16x16x32_bf16 v[36:39], v[130:133], v[110:113], v[36:39]
ds_read_b64 v[98:99], v245 offset:1088
v_mfma_f32_16x16x32_bf16 v[32:35], v[130:133], v[108:111], v[32:35]
ds_read_b64 v[96:97], v245 offset:1040
v_mfma_f32_16x16x32_bf16 v[28:31], v[130:133], v[106:109], v[28:31]
ds_read2_b32 v[190:191], v244 offset0:40 offset1:41
v_mfma_f32_16x16x32_bf16 v[24:27], v[130:133], v[104:107], v[24:27]
ds_read2_b32 v[192:193], v244 offset0:88 offset1:89
s_waitcnt lgkmcnt(7)
v_mfma_f32_16x16x32_bf16 v[20:23], v[130:133], v[102:105], v[20:23]
s_waitcnt lgkmcnt(6)
v_mfma_f32_16x16x32_bf16 v[16:19], v[130:133], v[100:103], v[16:19]
s_waitcnt lgkmcnt(8)
v_mfma_f32_16x16x32_bf16 v[44:47], v[134:137], v[110:113], v[44:47]
v_mfma_f32_16x16x32_bf16 v[40:43], v[134:137], v[108:111], v[40:43]
ds_read2_b32 v[130:131], v243 offset0:168 offset1:169
ds_read2_b32 v[132:133], v243 offset0:176 offset1:177
v_mfma_f32_16x16x32_bf16 v[36:39], v[134:137], v[106:109], v[36:39]
ds_read_b64 v[94:95], v245 offset:1008
v_mfma_f32_16x16x32_bf16 v[32:35], v[134:137], v[104:107], v[32:35]
ds_read_b64 v[92:93], v245 offset:976
v_mfma_f32_16x16x32_bf16 v[28:31], v[134:137], v[102:105], v[28:31]
ds_read2_b32 v[194:195], v244 offset0:64 offset1:65
v_mfma_f32_16x16x32_bf16 v[24:27], v[134:137], v[100:103], v[24:27]
ds_read2_b32 v[196:197], v244 offset0:112 offset1:113
s_waitcnt lgkmcnt(9)
v_mfma_f32_16x16x32_bf16 v[20:23], v[134:137], v[98:101], v[20:23]
s_waitcnt lgkmcnt(8)
v_mfma_f32_16x16x32_bf16 v[16:19], v[134:137], v[96:99], v[16:19]
s_waitcnt lgkmcnt(10)
v_mfma_f32_16x16x32_bf16 v[44:47], v[138:141], v[106:109], v[44:47]
v_mfma_f32_16x16x32_bf16 v[40:43], v[138:141], v[104:107], v[40:43]
ds_read2_b32 v[134:135], v243 offset0:152 offset1:153
ds_read2_b32 v[136:137], v243 offset0:160 offset1:161
v_mfma_f32_16x16x32_bf16 v[36:39], v[138:141], v[102:105], v[36:39]
ds_read_b64 v[90:91], v245 offset:944
v_mfma_f32_16x16x32_bf16 v[32:35], v[138:141], v[100:103], v[32:35]
ds_read_b64 v[88:89], v245 offset:912
v_mfma_f32_16x16x32_bf16 v[28:31], v[138:141], v[98:101], v[28:31]
ds_read2_b32 v[198:199], v244 offset0:32 offset1:33
v_mfma_f32_16x16x32_bf16 v[24:27], v[138:141], v[96:99], v[24:27]
ds_read2_b32 v[200:201], v244 offset0:80 offset1:81
s_waitcnt lgkmcnt(9)
v_mfma_f32_16x16x32_bf16 v[20:23], v[138:141], v[94:97], v[20:23]
s_waitcnt lgkmcnt(8)
v_mfma_f32_16x16x32_bf16 v[16:19], v[138:141], v[92:95], v[16:19]
s_waitcnt lgkmcnt(10)
v_mfma_f32_16x16x32_bf16 v[44:47], v[130:133], v[102:105], v[44:47]
v_mfma_f32_16x16x32_bf16 v[40:43], v[130:133], v[100:103], v[40:43]
ds_read2_b32 v[138:139], v243 offset0:136 offset1:137
ds_read2_b32 v[140:141], v243 offset0:144 offset1:145
v_mfma_f32_16x16x32_bf16 v[36:39], v[130:133], v[98:101], v[36:39]
ds_read_b64 v[86:87], v245 offset:880
v_mfma_f32_16x16x32_bf16 v[32:35], v[130:133], v[96:99], v[32:35]
ds_read_b64 v[84:85], v245 offset:848
v_mfma_f32_16x16x32_bf16 v[28:31], v[130:133], v[94:97], v[28:31]
ds_read2_b32 v[202:203], v244 offset0:56 offset1:57
v_mfma_f32_16x16x32_bf16 v[24:27], v[130:133], v[92:95], v[24:27]
ds_read2_b32 v[204:205], v244 offset0:104 offset1:105
s_waitcnt lgkmcnt(9)
v_mfma_f32_16x16x32_bf16 v[20:23], v[130:133], v[90:93], v[20:23]
s_waitcnt lgkmcnt(8)
v_mfma_f32_16x16x32_bf16 v[16:19], v[130:133], v[88:91], v[16:19]
s_waitcnt lgkmcnt(10)
v_mfma_f32_16x16x32_bf16 v[44:47], v[134:137], v[98:101], v[44:47]
v_mfma_f32_16x16x32_bf16 v[40:43], v[134:137], v[96:99], v[40:43]
ds_read2_b32 v[130:131], v243 offset0:120 offset1:121
ds_read2_b32 v[132:133], v243 offset0:128 offset1:129
v_mfma_f32_16x16x32_bf16 v[36:39], v[134:137], v[94:97], v[36:39]
ds_read_b64 v[82:83], v245 offset:816
v_mfma_f32_16x16x32_bf16 v[32:35], v[134:137], v[92:95], v[32:35]
ds_read_b64 v[80:81], v245 offset:768
v_mfma_f32_16x16x32_bf16 v[28:31], v[134:137], v[90:93], v[28:31]
ds_read2_b32 v[206:207], v244 offset0:24 offset1:25
v_mfma_f32_16x16x32_bf16 v[24:27], v[134:137], v[88:91], v[24:27]
ds_read2_b32 v[208:209], v244 offset0:72 offset1:73
s_waitcnt lgkmcnt(9)
v_mfma_f32_16x16x32_bf16 v[20:23], v[134:137], v[86:89], v[20:23]
s_waitcnt lgkmcnt(8)
v_mfma_f32_16x16x32_bf16 v[16:19], v[134:137], v[84:87], v[16:19]
s_waitcnt lgkmcnt(10)
v_mfma_f32_16x16x32_bf16 v[44:47], v[138:141], v[94:97], v[44:47]
v_mfma_f32_16x16x32_bf16 v[40:43], v[138:141], v[92:95], v[40:43]
ds_read2_b32 v[134:135], v243 offset0:104 offset1:105
ds_read2_b32 v[136:137], v243 offset0:112 offset1:113
v_mfma_f32_16x16x32_bf16 v[36:39], v[138:141], v[90:93], v[36:39]
ds_read_b64 v[78:79], v245 offset:736
v_mfma_f32_16x16x32_bf16 v[32:35], v[138:141], v[88:91], v[32:35]
ds_read_b64 v[76:77], v245 offset:704
v_mfma_f32_16x16x32_bf16 v[28:31], v[138:141], v[86:89], v[28:31]
ds_read2_b32 v[210:211], v244 offset0:48 offset1:49
v_mfma_f32_16x16x32_bf16 v[24:27], v[138:141], v[84:87], v[24:27]
ds_read2_b32 v[212:213], v244 offset0:96 offset1:97
s_waitcnt lgkmcnt(9)
v_mfma_f32_16x16x32_bf16 v[20:23], v[138:141], v[82:85], v[20:23]
s_waitcnt lgkmcnt(8)
v_mfma_f32_16x16x32_bf16 v[16:19], v[138:141], v[80:83], v[16:19]
s_waitcnt lgkmcnt(10)
v_mfma_f32_16x16x32_bf16 v[44:47], v[130:133], v[90:93], v[44:47]
v_mfma_f32_16x16x32_bf16 v[40:43], v[130:133], v[88:91], v[40:43]
ds_read2_b32 v[138:139], v243 offset0:88 offset1:89
ds_read2_b32 v[140:141], v243 offset0:96 offset1:97
v_mfma_f32_16x16x32_bf16 v[36:39], v[130:133], v[86:89], v[36:39]
ds_read_b64 v[74:75], v245 offset:672
v_mfma_f32_16x16x32_bf16 v[32:35], v[130:133], v[84:87], v[32:35]
ds_read_b64 v[72:73], v245 offset:640
v_mfma_f32_16x16x32_bf16 v[28:31], v[130:133], v[82:85], v[28:31]
ds_read_b128 v[142:145], v246 offset:0
v_mfma_f32_16x16x32_bf16 v[24:27], v[130:133], v[80:83], v[24:27]
ds_read_b128 v[146:149], v249 offset:0
s_waitcnt lgkmcnt(9)
v_mfma_f32_16x16x32_bf16 v[20:23], v[130:133], v[78:81], v[20:23]
s_waitcnt lgkmcnt(8)
v_mfma_f32_16x16x32_bf16 v[16:19], v[130:133], v[76:79], v[16:19]
s_waitcnt lgkmcnt(10)
v_mfma_f32_16x16x32_bf16 v[44:47], v[134:137], v[86:89], v[44:47]
v_mfma_f32_16x16x32_bf16 v[40:43], v[134:137], v[84:87], v[40:43]
ds_read2_b32 v[130:131], v243 offset0:72 offset1:73
ds_read2_b32 v[132:133], v243 offset0:80 offset1:81
v_mfma_f32_16x16x32_bf16 v[36:39], v[134:137], v[82:85], v[36:39]
ds_read_b64 v[70:71], v245 offset:608
v_mfma_f32_16x16x32_bf16 v[32:35], v[134:137], v[80:83], v[32:35]
ds_read_b64 v[68:69], v245 offset:576
v_mfma_f32_16x16x32_bf16 v[28:31], v[134:137], v[78:81], v[28:31]
ds_read_b128 v[150:153], v246 offset:544
v_mfma_f32_16x16x32_bf16 v[24:27], v[134:137], v[76:79], v[24:27]
ds_read_b128 v[154:157], v249 offset:544
s_waitcnt lgkmcnt(9)
v_mfma_f32_16x16x32_bf16 v[20:23], v[134:137], v[74:77], v[20:23]
s_waitcnt lgkmcnt(8)
v_mfma_f32_16x16x32_bf16 v[16:19], v[134:137], v[72:75], v[16:19]
s_waitcnt lgkmcnt(10)
v_mfma_f32_16x16x32_bf16 v[44:47], v[138:141], v[82:85], v[44:47]
v_mfma_f32_16x16x32_bf16 v[40:43], v[138:141], v[80:83], v[40:43]
ds_read2_b32 v[134:135], v243 offset0:56 offset1:57
ds_read2_b32 v[136:137], v243 offset0:64 offset1:65
v_mfma_f32_16x16x32_bf16 v[36:39], v[138:141], v[78:81], v[36:39]
ds_read_b64 v[66:67], v245 offset:544
v_mfma_f32_16x16x32_bf16 v[32:35], v[138:141], v[76:79], v[32:35]
ds_read_b64 v[64:65], v245 offset:496
v_mfma_f32_16x16x32_bf16 v[28:31], v[138:141], v[74:77], v[28:31]
ds_read_b128 v[158:161], v246 offset:1088
v_mfma_f32_16x16x32_bf16 v[24:27], v[138:141], v[72:75], v[24:27]
ds_read_b128 v[162:165], v249 offset:1088
s_waitcnt lgkmcnt(9)
v_mfma_f32_16x16x32_bf16 v[20:23], v[138:141], v[70:73], v[20:23]
s_waitcnt lgkmcnt(8)
v_mfma_f32_16x16x32_bf16 v[16:19], v[138:141], v[68:71], v[16:19]
s_waitcnt lgkmcnt(10)
v_mfma_f32_16x16x32_bf16 v[44:47], v[130:133], v[78:81], v[44:47]
v_mfma_f32_16x16x32_bf16 v[40:43], v[130:133], v[76:79], v[40:43]
ds_read2_b32 v[138:139], v243 offset0:40 offset1:41
ds_read2_b32 v[140:141], v243 offset0:48 offset1:49
v_mfma_f32_16x16x32_bf16 v[36:39], v[130:133], v[74:77], v[36:39]
ds_read_b64 v[62:63], v245 offset:464
v_mfma_f32_16x16x32_bf16 v[32:35], v[130:133], v[72:75], v[32:35]
ds_read_b64 v[60:61], v245 offset:432
v_mfma_f32_16x16x32_bf16 v[28:31], v[130:133], v[70:73], v[28:31]
ds_read_b128 v[166:169], v246 offset:1632
v_mfma_f32_16x16x32_bf16 v[24:27], v[130:133], v[68:71], v[24:27]
ds_read_b128 v[170:173], v249 offset:1632
s_waitcnt lgkmcnt(9)
v_mfma_f32_16x16x32_bf16 v[20:23], v[130:133], v[66:69], v[20:23]
s_waitcnt lgkmcnt(8)
v_mfma_f32_16x16x32_bf16 v[16:19], v[130:133], v[64:67], v[16:19]
s_waitcnt lgkmcnt(10)
v_mfma_f32_16x16x32_bf16 v[44:47], v[134:137], v[74:77], v[44:47]
v_mfma_f32_16x16x32_bf16 v[40:43], v[134:137], v[72:75], v[40:43]
ds_read2_b32 v[130:131], v243 offset0:24 offset1:25
ds_read2_b32 v[132:133], v243 offset0:32 offset1:33
v_mfma_f32_16x16x32_bf16 v[36:39], v[134:137], v[70:73], v[36:39]
ds_read_b64 v[58:59], v245 offset:400
v_mfma_f32_16x16x32_bf16 v[32:35], v[134:137], v[68:71], v[32:35]
ds_read_b64 v[56:57], v245 offset:368
v_mfma_f32_16x16x32_bf16 v[28:31], v[134:137], v[66:69], v[28:31]
ds_read_b128 v[174:177], v246 offset:2176
v_mfma_f32_16x16x32_bf16 v[24:27], v[134:137], v[64:67], v[24:27]
ds_read_b128 v[178:181], v249 offset:2176
s_waitcnt lgkmcnt(9)
v_mfma_f32_16x16x32_bf16 v[20:23], v[134:137], v[62:65], v[20:23]
s_waitcnt lgkmcnt(8)
v_mfma_f32_16x16x32_bf16 v[16:19], v[134:137], v[60:63], v[16:19]
s_waitcnt lgkmcnt(10)
v_mfma_f32_16x16x32_bf16 v[44:47], v[138:141], v[70:73], v[44:47]
v_mfma_f32_16x16x32_bf16 v[40:43], v[138:141], v[68:71], v[40:43]
ds_read2_b32 v[134:135], v243 offset0:8 offset1:9
ds_read2_b32 v[136:137], v243 offset0:16 offset1:17
v_mfma_f32_16x16x32_bf16 v[36:39], v[138:141], v[66:69], v[36:39]
ds_read_b64 v[54:55], v245 offset:336
v_mfma_f32_16x16x32_bf16 v[32:35], v[138:141], v[64:67], v[32:35]
ds_read_b64 v[52:53], v245 offset:304
v_mfma_f32_16x16x32_bf16 v[28:31], v[138:141], v[62:65], v[28:31]
ds_read_b128 v[182:185], v246 offset:2720
v_mfma_f32_16x16x32_bf16 v[24:27], v[138:141], v[60:63], v[24:27]
ds_read_b128 v[186:189], v249 offset:2720
s_waitcnt lgkmcnt(9)
v_mfma_f32_16x16x32_bf16 v[20:23], v[138:141], v[58:61], v[20:23]
s_waitcnt lgkmcnt(8)
v_mfma_f32_16x16x32_bf16 v[16:19], v[138:141], v[56:59], v[16:19]
s_waitcnt lgkmcnt(10)
v_mfma_f32_16x16x32_bf16 v[44:47], v[130:133], v[66:69], v[44:47]
v_mfma_f32_16x16x32_bf16 v[40:43], v[130:133], v[64:67], v[40:43]
ds_read_b64 v[50:51], v245 offset:272
v_mfma_f32_16x16x32_bf16 v[36:39], v[130:133], v[62:65], v[36:39]
ds_read_b64 v[48:49], v245 offset:224
v_mfma_f32_16x16x32_bf16 v[32:35], v[130:133], v[60:63], v[32:35]
v_mfma_f32_16x16x32_bf16 v[28:31], v[130:133], v[58:61], v[28:31]
v_mfma_f32_16x16x32_bf16 v[24:27], v[130:133], v[56:59], v[24:27]
s_waitcnt lgkmcnt(5)
v_mfma_f32_16x16x32_bf16 v[20:23], v[130:133], v[54:57], v[20:23]
s_waitcnt lgkmcnt(4)
v_mfma_f32_16x16x32_bf16 v[16:19], v[130:133], v[52:55], v[16:19]
s_waitcnt lgkmcnt(6)
v_mfma_f32_16x16x32_bf16 v[44:47], v[134:137], v[62:65], v[44:47]
v_mfma_f32_16x16x32_bf16 v[40:43], v[134:137], v[60:63], v[40:43]
v_mfma_f32_16x16x32_bf16 v[36:39], v[134:137], v[58:61], v[36:39]
v_mfma_f32_16x16x32_bf16 v[32:35], v[134:137], v[56:59], v[32:35]
v_mfma_f32_16x16x32_bf16 v[28:31], v[134:137], v[54:57], v[28:31]
v_mfma_f32_16x16x32_bf16 v[24:27], v[134:137], v[52:55], v[24:27]
s_waitcnt lgkmcnt(1)
v_mfma_f32_16x16x32_bf16 v[20:23], v[134:137], v[50:53], v[20:23]
s_waitcnt lgkmcnt(0)
v_mfma_f32_16x16x32_bf16 v[16:19], v[134:137], v[48:51], v[16:19]
s_waitcnt lgkmcnt(2)
v_mfma_f32_16x16x32_bf16 v[130:133], v[142:145], v[216:219], 0
v_mfma_f32_16x16x32_bf16 v[134:137], v[142:145], v[220:223], 0
v_mfma_f32_16x16x32_bf16 v[138:141], v[142:145], v[224:227], 0
ds_write_b128 v248, v[44:47] offset:448
v_mfma_f32_16x16x32_bf16 v[124:127], v[146:149], v[224:227], 0
s_nop 3
v_cvt_pk_bf16_f32 v48, v130, v131
v_cvt_pk_bf16_f32 v49, v132, v133
v_mfma_f32_16x16x32_bf16 v[130:133], v[142:145], v[228:231], 0
v_cvt_pk_bf16_f32 v50, v134, v135
v_cvt_pk_bf16_f32 v51, v136, v137
ds_write_b128 v248, v[40:43] offset:384
v_mfma_f32_16x16x32_bf16 v[134:137], v[146:149], v[232:235], 0
v_cvt_pk_bf16_f32 v72, v138, v139
v_cvt_pk_bf16_f32 v73, v140, v141
ds_write_b128 v248, v[36:39] offset:320
v_mfma_f32_16x16x32_bf16 v[138:141], v[142:145], v[236:239], 0
v_cvt_pk_bf16_f32 v74, v124, v125
v_cvt_pk_bf16_f32 v75, v126, v127
ds_write_b128 v248, v[32:35] offset:256
v_mfma_f32_16x16x32_bf16 v[124:127], v[150:153], v[216:219], 0
v_cvt_pk_bf16_f32 v96, v130, v131
v_cvt_pk_bf16_f32 v97, v132, v133
v_mfma_f32_16x16x32_bf16 v[130:133], v[150:153], v[220:223], 0
v_cvt_pk_bf16_f32 v98, v134, v135
v_cvt_pk_bf16_f32 v99, v136, v137
ds_write_b128 v248, v[28:31] offset:192
v_mfma_f32_16x16x32_bf16 v[134:137], v[150:153], v[224:227], 0
v_cvt_pk_bf16_f32 v112, v138, v139
v_cvt_pk_bf16_f32 v113, v140, v141
ds_write_b128 v248, v[24:27] offset:128
v_mfma_f32_16x16x32_bf16 v[138:141], v[154:157], v[224:227], 0
v_cvt_pk_bf16_f32 v52, v124, v125
v_cvt_pk_bf16_f32 v53, v126, v127
ds_write_b128 v248, v[20:23] offset:64
v_mfma_f32_16x16x32_bf16 v[124:127], v[150:153], v[228:231], 0
v_cvt_pk_bf16_f32 v54, v130, v131
v_cvt_pk_bf16_f32 v55, v132, v133
v_mfma_f32_16x16x32_bf16 v[130:133], v[154:157], v[232:235], 0
v_cvt_pk_bf16_f32 v76, v134, v135
v_cvt_pk_bf16_f32 v77, v136, v137
ds_write_b128 v248, v[16:19] offset:0
v_mfma_f32_16x16x32_bf16 v[134:137], v[150:153], v[236:239], 0
v_cvt_pk_bf16_f32 v78, v138, v139
v_cvt_pk_bf16_f32 v79, v140, v141
ds_read_b128 v[16:19], v250 offset:0
v_mfma_f32_16x16x32_bf16 v[138:141], v[158:161], v[216:219], 0
v_cvt_pk_bf16_f32 v100, v124, v125
v_cvt_pk_bf16_f32 v101, v126, v127
ds_read_b128 v[20:23], v250 offset:1056
v_mfma_f32_16x16x32_bf16 v[124:127], v[158:161], v[220:223], 0
v_cvt_pk_bf16_f32 v102, v130, v131
v_cvt_pk_bf16_f32 v103, v132, v133
v_mfma_f32_16x16x32_bf16 v[130:133], v[158:161], v[224:227], 0
v_cvt_pk_bf16_f32 v114, v134, v135
v_cvt_pk_bf16_f32 v115, v136, v137
ds_read_b128 v[24:27], v250 offset:2112
v_mfma_f32_16x16x32_bf16 v[134:137], v[162:165], v[224:227], 0
v_cvt_pk_bf16_f32 v56, v138, v139
v_cvt_pk_bf16_f32 v57, v140, v141
ds_read_b128 v[28:31], v250 offset:3168
v_mfma_f32_16x16x32_bf16 v[138:141], v[158:161], v[228:231], 0
v_cvt_pk_bf16_f32 v58, v124, v125
v_cvt_pk_bf16_f32 v59, v126, v127
ds_read_b128 v[32:35], v250 offset:4224
v_mfma_f32_16x16x32_bf16 v[124:127], v[162:165], v[232:235], 0
v_cvt_pk_bf16_f32 v80, v130, v131
v_cvt_pk_bf16_f32 v81, v132, v133
v_mfma_f32_16x16x32_bf16 v[130:133], v[158:161], v[236:239], 0
v_cvt_pk_bf16_f32 v82, v134, v135
v_cvt_pk_bf16_f32 v83, v136, v137
ds_read_b128 v[36:39], v250 offset:5280
v_mfma_f32_16x16x32_bf16 v[134:137], v[166:169], v[216:219], 0
v_cvt_pk_bf16_f32 v104, v138, v139
v_cvt_pk_bf16_f32 v105, v140, v141
ds_read_b128 v[40:43], v250 offset:6336
v_mfma_f32_16x16x32_bf16 v[138:141], v[166:169], v[220:223], 0
v_cvt_pk_bf16_f32 v106, v124, v125
v_cvt_pk_bf16_f32 v107, v126, v127
ds_read_b128 v[44:47], v250 offset:7392
v_mfma_f32_16x16x32_bf16 v[124:127], v[166:169], v[224:227], 0
v_cvt_pk_bf16_f32 v116, v130, v131
v_cvt_pk_bf16_f32 v117, v132, v133
v_mfma_f32_16x16x32_bf16 v[130:133], v[170:173], v[224:227], 0
v_cvt_pk_bf16_f32 v60, v134, v135
v_cvt_pk_bf16_f32 v61, v136, v137
ds_read2_b32 v[120:121], v244 offset0:200 offset1:201
v_mfma_f32_16x16x32_bf16 v[134:137], v[166:169], v[228:231], 0
v_cvt_pk_bf16_f32 v62, v138, v139
v_cvt_pk_bf16_f32 v63, v140, v141
ds_read2_b32 v[142:143], v244 offset0:152 offset1:153
v_mfma_f32_16x16x32_bf16 v[138:141], v[170:173], v[232:235], 0
v_cvt_pk_bf16_f32 v84, v124, v125
v_cvt_pk_bf16_f32 v85, v126, v127
ds_read2_b32 v[144:145], v244 offset0:192 offset1:193
v_mfma_f32_16x16x32_bf16 v[124:127], v[166:169], v[236:239], 0
v_cvt_pk_bf16_f32 v86, v130, v131
v_cvt_pk_bf16_f32 v87, v132, v133
v_mfma_f32_16x16x32_bf16 v[130:133], v[174:177], v[216:219], 0
v_cvt_pk_bf16_f32 v108, v134, v135
v_cvt_pk_bf16_f32 v109, v136, v137
ds_read2_b32 v[146:147], v244 offset0:144 offset1:145
v_mfma_f32_16x16x32_bf16 v[134:137], v[174:177], v[220:223], 0
v_cvt_pk_bf16_f32 v110, v138, v139
v_cvt_pk_bf16_f32 v111, v140, v141
ds_read2_b32 v[148:149], v244 offset0:184 offset1:185
v_mfma_f32_16x16x32_bf16 v[138:141], v[174:177], v[224:227], 0
v_cvt_pk_bf16_f32 v118, v124, v125
v_cvt_pk_bf16_f32 v119, v126, v127
ds_read2_b32 v[150:151], v244 offset0:136 offset1:137
v_mfma_f32_16x16x32_bf16 v[124:127], v[178:181], v[224:227], 0
v_cvt_pk_bf16_f32 v64, v130, v131
v_cvt_pk_bf16_f32 v65, v132, v133
v_mfma_f32_16x16x32_bf16 v[130:133], v[182:185], v[216:219], 0
v_cvt_pk_bf16_f32 v66, v134, v135
v_cvt_pk_bf16_f32 v67, v136, v137
ds_read2_b32 v[152:153], v244 offset0:176 offset1:177
v_mfma_f32_16x16x32_bf16 v[134:137], v[182:185], v[220:223], 0
v_cvt_pk_bf16_f32 v88, v138, v139
v_cvt_pk_bf16_f32 v89, v140, v141
ds_read2_b32 v[154:155], v244 offset0:128 offset1:129
v_mfma_f32_16x16x32_bf16 v[138:141], v[182:185], v[224:227], 0
v_cvt_pk_bf16_f32 v90, v124, v125
v_cvt_pk_bf16_f32 v91, v126, v127
ds_read2_b32 v[156:157], v244 offset0:168 offset1:169
v_mfma_f32_16x16x32_bf16 v[124:127], v[186:189], v[224:227], 0
v_cvt_pk_bf16_f32 v68, v130, v131
v_cvt_pk_bf16_f32 v69, v132, v133
v_mov_b32 v122, 0
v_mov_b32 v123, 0
v_cvt_pk_bf16_f32 v70, v134, v135
v_cvt_pk_bf16_f32 v71, v136, v137
v_cvt_pk_bf16_f32 v92, v138, v139
v_cvt_pk_bf16_f32 v93, v140, v141
v_cvt_pk_bf16_f32 v94, v124, v125
v_cvt_pk_bf16_f32 v95, v126, v127
s_waitcnt lgkmcnt(14)
v_mfma_f32_16x16x32_bf16 v[24:27], v[48:51], v[190:193], v[24:27]
v_cvt_pk_bf16_f32 v216, v16, v17
v_mfma_f32_16x16x32_bf16 v[24:27], v[72:75], v[194:197], v[24:27]
v_cvt_pk_bf16_f32 v217, v18, v19
s_waitcnt lgkmcnt(13)
v_mfma_f32_16x16x32_bf16 v[28:31], v[52:55], v[190:193], v[28:31]
v_cvt_pk_bf16_f32 v218, v20, v21
v_mfma_f32_16x16x32_bf16 v[28:31], v[76:79], v[194:197], v[28:31]
v_cvt_pk_bf16_f32 v219, v22, v23
v_mfma_f32_16x16x32_bf16 v[28:31], v[48:51], v[198:201], v[28:31]
v_permlane16_swap_b32 v216, v218
v_mfma_f32_16x16x32_bf16 v[28:31], v[72:75], v[202:205], v[28:31]
v_permlane16_swap_b32 v217, v219
s_waitcnt lgkmcnt(12)
v_mfma_f32_16x16x32_bf16 v[32:35], v[56:59], v[190:193], v[32:35]
v_mfma_f32_16x16x32_bf16 v[32:35], v[80:83], v[194:197], v[32:35]
v_mfma_f32_16x16x32_bf16 v[32:35], v[52:55], v[198:201], v[32:35]
v_mfma_f32_16x16x32_bf16 v[32:35], v[76:79], v[202:205], v[32:35]
v_mfma_f32_16x16x32_bf16 v[32:35], v[48:51], v[206:209], v[32:35]
buffer_store_dwordx4 v[216:219], v247, s[32:35], s78 offen offset:0 sc1
v_mfma_f32_16x16x32_bf16 v[32:35], v[72:75], v[210:213], v[32:35]
v_cvt_pk_bf16_f32 v220, v24, v25
s_waitcnt lgkmcnt(6)
v_mfma_f32_16x16x32_bf16 v[32:35], v[96:99], v[142:145], v[32:35]
v_cvt_pk_bf16_f32 v221, v26, v27
s_waitcnt lgkmcnt(8)
v_mfma_f32_16x16x32_bf16 v[32:35], v[112:115], v[120:123], v[32:35]
v_cvt_pk_bf16_f32 v222, v28, v29
s_waitcnt lgkmcnt(11)
v_mfma_f32_16x16x32_bf16 v[36:39], v[60:63], v[190:193], v[36:39]
v_cvt_pk_bf16_f32 v223, v30, v31
v_mfma_f32_16x16x32_bf16 v[36:39], v[84:87], v[194:197], v[36:39]
v_permlane16_swap_b32 v220, v222
v_mfma_f32_16x16x32_bf16 v[36:39], v[56:59], v[198:201], v[36:39]
v_permlane16_swap_b32 v221, v223
v_mfma_f32_16x16x32_bf16 v[36:39], v[80:83], v[202:205], v[36:39]
buffer_store_dwordx4 v[220:223], v247, s[32:35], s78 offen offset:1024 sc1
v_mfma_f32_16x16x32_bf16 v[36:39], v[52:55], v[206:209], v[36:39]
v_mfma_f32_16x16x32_bf16 v[36:39], v[76:79], v[210:213], v[36:39]
v_mfma_f32_16x16x32_bf16 v[36:39], v[100:103], v[142:145], v[36:39]
s_waitcnt lgkmcnt(4)
v_mfma_f32_16x16x32_bf16 v[36:39], v[96:99], v[146:149], v[36:39]
v_mfma_f32_16x16x32_bf16 v[36:39], v[114:117], v[120:123], v[36:39]
s_waitcnt lgkmcnt(10)
v_mfma_f32_16x16x32_bf16 v[40:43], v[64:67], v[190:193], v[40:43]
v_mfma_f32_16x16x32_bf16 v[40:43], v[88:91], v[194:197], v[40:43]
v_mfma_f32_16x16x32_bf16 v[40:43], v[60:63], v[198:201], v[40:43]
v_mfma_f32_16x16x32_bf16 v[40:43], v[84:87], v[202:205], v[40:43]
v_mfma_f32_16x16x32_bf16 v[40:43], v[56:59], v[206:209], v[40:43]
v_cvt_pk_bf16_f32 v224, v32, v33
v_mfma_f32_16x16x32_bf16 v[40:43], v[80:83], v[210:213], v[40:43]
v_cvt_pk_bf16_f32 v225, v34, v35
v_mfma_f32_16x16x32_bf16 v[40:43], v[104:107], v[142:145], v[40:43]
v_cvt_pk_bf16_f32 v226, v36, v37
v_mfma_f32_16x16x32_bf16 v[40:43], v[100:103], v[146:149], v[40:43]
v_cvt_pk_bf16_f32 v227, v38, v39
s_waitcnt lgkmcnt(2)
v_mfma_f32_16x16x32_bf16 v[40:43], v[96:99], v[150:153], v[40:43]
v_permlane16_swap_b32 v224, v226
v_mfma_f32_16x16x32_bf16 v[40:43], v[116:119], v[120:123], v[40:43]
v_permlane16_swap_b32 v225, v227
s_waitcnt lgkmcnt(9)
v_mfma_f32_16x16x32_bf16 v[44:47], v[68:71], v[190:193], v[44:47]
buffer_store_dwordx4 v[224:227], v247, s[32:35], s78 offen offset:2048 sc1
v_mfma_f32_16x16x32_bf16 v[44:47], v[92:95], v[194:197], v[44:47]
v_mfma_f32_16x16x32_bf16 v[44:47], v[64:67], v[198:201], v[44:47]
v_mfma_f32_16x16x32_bf16 v[44:47], v[88:91], v[202:205], v[44:47]
v_mfma_f32_16x16x32_bf16 v[44:47], v[60:63], v[206:209], v[44:47]
v_mfma_f32_16x16x32_bf16 v[44:47], v[84:87], v[210:213], v[44:47]
v_mfma_f32_16x16x32_bf16 v[44:47], v[108:111], v[142:145], v[44:47]
v_mfma_f32_16x16x32_bf16 v[44:47], v[104:107], v[146:149], v[44:47]
v_mfma_f32_16x16x32_bf16 v[44:47], v[100:103], v[150:153], v[44:47]
s_waitcnt lgkmcnt(0)
v_mfma_f32_16x16x32_bf16 v[44:47], v[96:99], v[154:157], v[44:47]
v_mfma_f32_16x16x32_bf16 v[44:47], v[118:121], v[120:123], v[44:47]
v_cvt_pk_bf16_f32 v228, v40, v41
v_cvt_pk_bf16_f32 v229, v42, v43
s_nop 5
v_cvt_pk_bf16_f32 v230, v44, v45
v_cvt_pk_bf16_f32 v231, v46, v47
s_nop 0
v_permlane16_swap_b32 v228, v230
v_permlane16_swap_b32 v229, v231
buffer_store_dwordx4 v[228:231], v247, s[32:35], s78 offen offset:3072 sc1
v_mov_b32 v10, 0
s_waitcnt vmcnt(0)
s_barrier
s_cmp_lg_u32 s66, 0
s_cbranch_scc1 L_pub_28
v_mov_b32 v5, s1
s_mov_b64 exec, 1
buffer_store_dword v5, v10, s[24:27], s0 offen sc1
s_mov_b64 exec, -1
L_pub_28:
s_cmp_lg_u32 s68, 19
s_cbranch_scc1 L_noep_29
s_cmp_lg_u32 s66, 0
s_cbranch_scc1 L_noep_29
s_setprio 0
v_mov_b32 v8, 0
v_lshlrev_b32 v2, 7, v0
v_add_u32 v2, 24576, v2
s_mov_b32 s71, 7
L_ep_30:
v_min_u32 v3, 75648, v2
s_mov_b32 s72, 4531
L_poll_31:
buffer_load_dword v9, v3, s[24:27], 0 offen sc1
s_waitcnt vmcnt(0)
v_cmp_ne_u32 vcc, s1, v9
s_cbranch_vccz L_pollok_32
s_sleep 32
s_sub_u32 s72, s72, 1
s_cbranch_scc0 L_poll_31
L_pollok_32:
v_add_u32 v2, 8192, v2
s_sub_u32 s71, s71, 1
s_cmp_lg_u32 s71, 0
s_cbranch_scc1 L_ep_30
v_min_u32 v3, 15, v0
v_lshlrev_b32 v3, 7, v3
v_add_u32 v3, 4096, v3
s_mov_b32 s72, 4531
L_poll_33:
buffer_load_dword v9, v3, s[24:27], 0 offen sc1
s_waitcnt vmcnt(0)
v_cmp_ne_u32 vcc, s1, v9
s_cbranch_vccz L_pollok_34
s_sleep 32
s_sub_u32 s72, s72, 1
s_cbranch_scc0 L_poll_33
L_pollok_34:
v_min_u32 v3, 47, v0
v_lshlrev_b32 v3, 7, v3
v_add_u32 v3, 8192, v3
s_mov_b32 s72, 4531
L_poll_35:
buffer_load_dword v9, v3, s[24:27], 0 offen sc1
s_waitcnt vmcnt(0)
v_cmp_ne_u32 vcc, s1, v9
s_cbranch_vccz L_pollok_36
s_sleep 32
s_sub_u32 s72, s72, 1
s_cbranch_scc0 L_poll_35
L_pollok_36:
v_min_u32 v3, 47, v0
v_lshlrev_b32 v3, 7, v3
v_add_u32 v3, 14336, v3
s_mov_b32 s72, 4531
L_poll_37:
buffer_load_dword v9, v3, s[24:27], 0 offen sc1
s_waitcnt vmcnt(0)
v_cmp_ne_u32 vcc, s1, v9
s_cbranch_vccz L_pollok_38
s_sleep 32
s_sub_u32 s72, s72, 1
s_cbranch_scc0 L_poll_37
L_pollok_38:
v_mov_b32 v2, s1
s_mov_b64 exec, 1
buffer_store_dword v2, v8, s[24:27], 0 offen sc1
s_mov_b64 exec, -1
L_noep_29:
s_branch L_done
L_g2:
s_add_u32 s8, s64, 12582912
s_addc_u32 s9, s65, 0
s_mov_b32 s10, 1966080
s_mov_b32 s11, 0x20000
s_lshr_b32 s70, s67, 3
s_and_b32 s69, s67, 7
v_lshlrev_b32 v1, 4, v0
s_mul_i32 s31, s70, 3
s_mul_i32 s73, s69, 3
s_lshr_b32 s73, s73, 1
s_add_u32 s31, s31, s73
s_sub_u32 s73, s31, 12
s_cselect_b32 s31, s31, s73
s_mul_i32 s30, s66, 12288
s_mul_i32 s32, s69, 245760
s_add_u32 s32, s32, s30
s_add_u32 s33, s32, 49152
s_add_u32 s34, s32, 98304
s_add_u32 s35, s32, 147456
s_add_u32 s78, s32, 196608
v_mov_b32 v10, 0
s_cmp_lt_u32 s67, 12
s_cbranch_scc1 L_g2slow_39
s_cmp_eq_u32 s50, 0
s_cbranch_scc1 L_g2full_42
s_lshl_b32 s80, s31, 10
v_add_u32 v2, s80, v1
buffer_load_dwordx4 v[76:79], v2, s[8:11], s32 offen sc1
s_waitcnt vmcnt(1)
s_barrier
s_cmp_eq_u32 s0, 0
s_cbranch_scc1 L_nopub_43
s_cmp_lg_u32 s66, 3
s_cbranch_scc1 L_pub_44
v_mov_b32 v5, s1
s_mov_b64 exec, 1
buffer_store_dword v5, v10, s[24:27], s0 offen sc1
s_mov_b64 exec, -1
L_pub_44:
L_nopub_43:
buffer_load_dwordx4 v[80:83], v2, s[8:11], s33 offen sc1
s_lshl_b32 s68, s3, 2
s_add_u32 s68, s68, s70
s_mul_i32 s79, s66, 1024
v_add_u32 v9, s79, v1
s_and_b32 s70, s68, 7
buffer_load_dwordx4 v[84:87], v2, s[8:11], s34 offen sc1
s_lshl_b32 s70, s70, 2
s_bitcmp1_b32 s68, 3
s_mov_b32 s71, 554762240
s_cmov_b32 s71, 1145254690
s_mov_b32 s72, 554766336
s_cmov_b32 s72, 1145254690
buffer_load_dwordx4 v[88:91], v2, s[8:11], s35 offen sc1
s_lshr_b32 s71, s71, s70
s_lshr_b32 s72, s72, s70
s_and_b32 s71, s71, 15
s_and_b32 s72, s72, 15
s_lshr_b32 s70, s68, 4
buffer_load_dwordx4 v[92:95], v2, s[8:11], s78 offen sc1
s_mul_i32 s70, s70, 5
s_add_u32 s71, s71, s70
s_add_u32 s72, s72, s70
s_mul_i32 s71, s71, 3072
s_mul_i32 s72, s72, 3072
s_add_u32 s81, s31, 1
s_sub_u32 s73, s81, 12
s_cselect_b32 s81, s81, s73
s_lshl_b32 s81, s81, 10
v_add_u32 v3, s81, v1
buffer_load_dwordx4 v[96:99], v3, s[8:11], s32 offen sc1
v_mov_b32 v11, s71
v_mov_b32 v12, s72
v_cmp_gt_u32 vcc, 32, v0
s_nop 1
v_cndmask_b32 v11, v12, v11, vcc
v_and_b32 v12, 31, v0
buffer_load_dwordx4 v[100:103], v3, s[8:11], s33 offen sc1
v_min_u32 v12, 23, v12
v_lshl_add_u32 v4, v12, 7, v11
v_add_u32 v4, 24576, v4
s_mul_i32 s71, s68, 196608
s_add_u32 s71, s71, s30
buffer_load_dwordx4 v[104:107], v3, s[8:11], s34 offen sc1
s_add_u32 s70, s66, 1
s_and_b32 s70, s70, 3
s_mul_i32 s70, s70, 49152
s_add_u32 s74, s71, s70
s_add_u32 s70, s66, 2
buffer_load_dwordx4 v[108:111], v3, s[8:11], s35 offen sc1
s_and_b32 s70, s70, 3
s_mul_i32 s70, s70, 49152
s_add_u32 s75, s71, s70
s_add_u32 s70, s66, 3
s_and_b32 s70, s70, 3
buffer_load_dwordx4 v[112:115], v3, s[8:11], s78 offen sc1
s_mul_i32 s70, s70, 49152
s_add_u32 s76, s71, s70
s_add_u32 s70, s66, 4
s_and_b32 s70, s70, 3
s_mul_i32 s70, s70, 49152
s_add_u32 s82, s31, 2
s_sub_u32 s73, s82, 12
s_cselect_b32 s82, s82, s73
s_lshl_b32 s82, s82, 10
v_add_u32 v2, s82, v1
buffer_load_dwordx4 v[116:119], v2, s[8:11], s32 offen sc1
s_add_u32 s77, s71, s70
s_add_u32 s4, s64, 1048576
s_addc_u32 s5, s65, 0
s_mov_b32 s6, 6291456
s_mov_b32 s7, 0x20000
buffer_load_dwordx4 v[120:123], v2, s[8:11], s33 offen sc1
s_add_u32 s12, s64, 8388608
s_addc_u32 s13, s65, 0
s_mov_b32 s14, 2703360
s_mov_b32 s15, 0x20000
s_add_u32 s16, s64, 15728640
s_addc_u32 s17, s65, 0
s_waitcnt vmcnt(11)
buffer_load_dwordx4 v[124:127], v2, s[8:11], s34 offen sc1
s_mov_b32 s18, 16384
s_mov_b32 s19, 0x20000
s_mov_b32 s20, s60
s_mov_b32 s21, s61
s_mov_b32 s22, 2621440
s_waitcnt vmcnt(11)
buffer_load_dwordx4 v[128:131], v2, s[8:11], s35 offen sc1
s_mov_b32 s23, 0x20000
v_and_b32 v8, 15, v0
s_lshl_b32 s70, s68, 6
s_lshl_b32 s71, s66, 4
s_add_u32 s70, s70, s71
s_waitcnt vmcnt(11)
buffer_load_dwordx4 v[132:135], v2, s[8:11], s78 offen sc1
v_add_u32 v8, s70, v8
v_lshlrev_b32 v14, 3, v8
s_add_u32 s83, s31, 3
s_sub_u32 s73, s83, 12
s_cselect_b32 s83, s83, s73
s_lshl_b32 s83, s83, 10
v_add_u32 v3, s83, v1
s_waitcnt vmcnt(11)
buffer_load_dwordx4 v[136:139], v3, s[8:11], s32 offen sc1
s_add_u32 s86, s31, 6
s_sub_u32 s73, s86, 12
s_cselect_b32 s86, s86, s73
s_lshl_b32 s86, s86, 10
s_waitcnt vmcnt(11)
buffer_load_dwordx4 v[140:143], v3, s[8:11], s33 offen sc1
s_add_u32 s87, s31, 7
s_sub_u32 s73, s87, 12
s_cselect_b32 s87, s87, s73
s_lshl_b32 s87, s87, 10
s_waitcnt vmcnt(11)
buffer_load_dwordx4 v[144:147], v3, s[8:11], s34 offen sc1
s_add_u32 s88, s31, 8
s_sub_u32 s73, s88, 12
s_cselect_b32 s88, s88, s73
s_lshl_b32 s88, s88, 10
s_waitcnt vmcnt(11)
buffer_load_dwordx4 v[148:151], v3, s[8:11], s35 offen sc1
s_add_u32 s89, s31, 9
s_sub_u32 s73, s89, 12
s_cselect_b32 s89, s89, s73
s_lshl_b32 s89, s89, 10
s_waitcnt vmcnt(11)
buffer_load_dwordx4 v[152:155], v3, s[8:11], s78 offen sc1
s_add_u32 s90, s31, 10
s_sub_u32 s73, s90, 12
s_cselect_b32 s90, s90, s73
s_lshl_b32 s90, s90, 10
s_add_u32 s84, s31, 4
s_sub_u32 s73, s84, 12
s_cselect_b32 s84, s84, s73
s_lshl_b32 s84, s84, 10
v_add_u32 v2, s84, v1
s_waitcnt vmcnt(11)
buffer_load_dwordx4 v[156:159], v2, s[8:11], s32 offen sc1
s_add_u32 s91, s31, 11
s_sub_u32 s73, s91, 12
s_cselect_b32 s91, s91, s73
s_lshl_b32 s91, s91, 10
s_waitcnt vmcnt(11)
buffer_load_dwordx4 v[160:163], v2, s[8:11], s33 offen sc1
v_lshrrev_b32 v11, 3, v0
v_and_b32 v12, 7, v0
v_mul_u32_u24 v6, 128, v11
v_lshl_add_u32 v6, v12, 4, v6
s_add_u32 s70, s79, 61440
s_waitcnt vmcnt(11)
buffer_load_dwordx4 v[164:167], v2, s[8:11], s34 offen sc1
v_add_u32 v6, s70, v6
s_lshl_b32 s70, s66, 3
v_add_u32 v11, s70, v11
v_mul_u32_u24 v7, 4224, v11
v_lshl_add_u32 v7, v12, 4, v7
s_waitcnt vmcnt(11)
buffer_load_dwordx4 v[168:171], v2, s[8:11], s35 offen sc1
v_min_u32 v13, 19, v0
s_mul_i32 s70, s69, 2560
s_add_u32 s70, s70, 55296
v_lshl_add_u32 v13, v13, 7, s70
s_lshr_b32 s70, s68, 1
buffer_load_dword v15, v4, s[24:27], 0 offen sc1
s_waitcnt vmcnt(11)
buffer_load_dwordx4 v[172:175], v2, s[8:11], s78 offen sc1
s_lshl_b32 s70, s70, 7
s_add_u32 s70, s70, 4096
v_mov_b32 v12, s70
v_cmp_gt_u32 vcc, 20, v0
s_nop 1
v_cndmask_b32 v13, v12, v13, vcc
s_add_u32 s85, s31, 5
s_sub_u32 s73, s85, 12
s_cselect_b32 s85, s85, s73
s_lshl_b32 s85, s85, 10
v_add_u32 v3, s85, v1
s_waitcnt vmcnt(11)
buffer_load_dwordx4 v[176:179], v3, s[8:11], s32 offen sc1
s_mul_i32 s70, s69, 337920
s_lshl_b32 s71, s68, 7
s_add_u32 s70, s70, s71
s_add_u32 s71, s70, 135168
s_add_u32 s72, s70, 270336
s_waitcnt vmcnt(11)
buffer_load_dwordx4 v[180:183], v3, s[8:11], s33 offen sc1
s_cmp_ge_u32 s66, 2
s_cselect_b32 s72, 0x8000000, s72
s_waitcnt vmcnt(11)
buffer_load_dwordx4 v[184:187], v3, s[8:11], s34 offen sc1
s_waitcnt vmcnt(11)
buffer_load_dwordx4 v[188:191], v3, s[8:11], s35 offen sc1
s_waitcnt vmcnt(11)
buffer_load_dwordx4 v[192:195], v3, s[8:11], s78 offen sc1
s_branch L_g2pk_41
L_g2full_42:
s_lshl_b32 s68, s3, 2
s_add_u32 s68, s68, s70
s_mul_i32 s79, s66, 1024
v_add_u32 v9, s79, v1
s_mul_i32 s71, s68, 196608
s_add_u32 s71, s71, s30
s_add_u32 s70, s66, 1
s_and_b32 s70, s70, 3
s_mul_i32 s70, s70, 49152
s_add_u32 s74, s71, s70
s_add_u32 s70, s66, 2
s_and_b32 s70, s70, 3
s_mul_i32 s70, s70, 49152
s_add_u32 s75, s71, s70
s_add_u32 s70, s66, 3
s_and_b32 s70, s70, 3
s_mul_i32 s70, s70, 49152
s_add_u32 s76, s71, s70
s_add_u32 s70, s66, 4
s_and_b32 s70, s70, 3
s_mul_i32 s70, s70, 49152
s_add_u32 s77, s71, s70
s_add_u32 s4, s64, 1048576
s_addc_u32 s5, s65, 0
s_mov_b32 s6, 6291456
s_mov_b32 s7, 0x20000
s_add_u32 s12, s64, 8388608
s_addc_u32 s13, s65, 0
s_mov_b32 s14, 2703360
s_mov_b32 s15, 0x20000
s_add_u32 s16, s64, 15728640
s_addc_u32 s17, s65, 0
s_mov_b32 s18, 16384
s_mov_b32 s19, 0x20000
s_mov_b32 s20, s60
s_mov_b32 s21, s61
s_mov_b32 s22, 2621440
s_mov_b32 s23, 0x20000
v_and_b32 v8, 15, v0
s_lshl_b32 s70, s68, 6
s_lshl_b32 s71, s66, 4
s_add_u32 s70, s70, s71
v_add_u32 v8, s70, v8
v_lshlrev_b32 v14, 3, v8
s_lshl_b32 s80, s31, 10
s_add_u32 s81, s31, 1
s_sub_u32 s73, s81, 12
s_cselect_b32 s81, s81, s73
s_lshl_b32 s81, s81, 10
s_add_u32 s82, s31, 2
s_sub_u32 s73, s82, 12
s_cselect_b32 s82, s82, s73
s_lshl_b32 s82, s82, 10
s_add_u32 s83, s31, 3
s_sub_u32 s73, s83, 12
s_cselect_b32 s83, s83, s73
s_lshl_b32 s83, s83, 10
s_add_u32 s84, s31, 4
s_sub_u32 s73, s84, 12
s_cselect_b32 s84, s84, s73
s_lshl_b32 s84, s84, 10
s_add_u32 s85, s31, 5
s_sub_u32 s73, s85, 12
s_cselect_b32 s85, s85, s73
s_lshl_b32 s85, s85, 10
s_add_u32 s86, s31, 6
s_sub_u32 s73, s86, 12
s_cselect_b32 s86, s86, s73
s_lshl_b32 s86, s86, 10
s_add_u32 s87, s31, 7
s_sub_u32 s73, s87, 12
s_cselect_b32 s87, s87, s73
s_lshl_b32 s87, s87, 10
s_add_u32 s88, s31, 8
s_sub_u32 s73, s88, 12
s_cselect_b32 s88, s88, s73
s_lshl_b32 s88, s88, 10
s_add_u32 s89, s31, 9
s_sub_u32 s73, s89, 12
s_cselect_b32 s89, s89, s73
s_lshl_b32 s89, s89, 10
s_add_u32 s90, s31, 10
s_sub_u32 s73, s90, 12
s_cselect_b32 s90, s90, s73
s_lshl_b32 s90, s90, 10
s_add_u32 s91, s31, 11
s_sub_u32 s73, s91, 12
s_cselect_b32 s91, s91, s73
s_lshl_b32 s91, s91, 10
v_add_u32 v2, s86, v1
buffer_load_dwordx4 v[16:19], v2, s[8:11], s32 offen sc1
buffer_load_dwordx4 v[20:23], v2, s[8:11], s33 offen sc1
buffer_load_dwordx4 v[24:27], v2, s[8:11], s34 offen sc1
buffer_load_dwordx4 v[28:31], v2, s[8:11], s35 offen sc1
buffer_load_dwordx4 v[32:35], v2, s[8:11], s78 offen sc1
v_add_u32 v3, s87, v1
buffer_load_dwordx4 v[36:39], v3, s[8:11], s32 offen sc1
buffer_load_dwordx4 v[40:43], v3, s[8:11], s33 offen sc1
buffer_load_dwordx4 v[44:47], v3, s[8:11], s34 offen sc1
buffer_load_dwordx4 v[48:51], v3, s[8:11], s35 offen sc1
buffer_load_dwordx4 v[52:55], v3, s[8:11], s78 offen sc1
v_add_u32 v2, s88, v1
buffer_load_dwordx4 v[56:59], v2, s[8:11], s32 offen sc1
buffer_load_dwordx4 v[60:63], v2, s[8:11], s33 offen sc1
buffer_load_dwordx4 v[64:67], v2, s[8:11], s34 offen sc1
buffer_load_dwordx4 v[68:71], v2, s[8:11], s35 offen sc1
buffer_load_dwordx4 v[72:75], v2, s[8:11], s78 offen sc1
v_add_u32 v3, s89, v1
buffer_load_dwordx4 v[196:199], v3, s[8:11], s32 offen sc1
s_waitcnt vmcnt(15)
s_barrier
s_cmp_eq_u32 s0, 0
s_cbranch_scc1 L_nopub_45
s_cmp_lg_u32 s66, 3
s_cbranch_scc1 L_pub_46
v_mov_b32 v5, s1
s_mov_b64 exec, 1
buffer_store_dword v5, v10, s[24:27], s0 offen sc1
s_mov_b64 exec, -1
L_pub_46:
L_nopub_45:
ds_write_b128 v9, v[16:19] offset:0
buffer_load_dwordx4 v[200:203], v3, s[8:11], s33 offen sc1
s_waitcnt vmcnt(15)
ds_write_b128 v9, v[20:23] offset:4096
buffer_load_dwordx4 v[204:207], v3, s[8:11], s34 offen sc1
s_waitcnt vmcnt(15)
ds_write_b128 v9, v[24:27] offset:8192
buffer_load_dwordx4 v[208:211], v3, s[8:11], s35 offen sc1
s_waitcnt vmcnt(15)
ds_write_b128 v9, v[28:31] offset:12288
buffer_load_dwordx4 v[212:215], v3, s[8:11], s78 offen sc1
v_add_u32 v2, s80, v1
s_waitcnt vmcnt(15)
ds_write_b128 v9, v[32:35] offset:16384
buffer_load_dwordx4 v[76:79], v2, s[8:11], s32 offen sc1
s_waitcnt vmcnt(15)
ds_write_b128 v9, v[36:39] offset:20480
buffer_load_dwordx4 v[80:83], v2, s[8:11], s33 offen sc1
s_waitcnt vmcnt(15)
ds_write_b128 v9, v[40:43] offset:24576
buffer_load_dwordx4 v[84:87], v2, s[8:11], s34 offen sc1
s_waitcnt vmcnt(15)
ds_write_b128 v9, v[44:47] offset:28672
buffer_load_dwordx4 v[88:91], v2, s[8:11], s35 offen sc1
s_waitcnt vmcnt(15)
ds_write_b128 v9, v[48:51] offset:32768
buffer_load_dwordx4 v[92:95], v2, s[8:11], s78 offen sc1
v_add_u32 v3, s81, v1
s_waitcnt vmcnt(15)
ds_write_b128 v9, v[52:55] offset:36864
buffer_load_dwordx4 v[96:99], v3, s[8:11], s32 offen sc1
s_waitcnt vmcnt(15)
ds_write_b128 v9, v[56:59] offset:40960
buffer_load_dwordx4 v[100:103], v3, s[8:11], s33 offen sc1
s_waitcnt vmcnt(15)
ds_write_b128 v9, v[60:63] offset:45056
buffer_load_dwordx4 v[104:107], v3, s[8:11], s34 offen sc1
s_waitcnt vmcnt(15)
ds_write_b128 v9, v[64:67] offset:49152
buffer_load_dwordx4 v[108:111], v3, s[8:11], s35 offen sc1
s_waitcnt vmcnt(15)
ds_write_b128 v9, v[68:71] offset:53248
buffer_load_dwordx4 v[112:115], v3, s[8:11], s78 offen sc1
v_add_u32 v2, s82, v1
s_waitcnt vmcnt(15)
ds_write_b128 v9, v[72:75] offset:57344
buffer_load_dwordx4 v[116:119], v2, s[8:11], s32 offen sc1
s_waitcnt vmcnt(15)
ds_write_b128 v9, v[196:199] offset:61440
buffer_load_dwordx4 v[120:123], v2, s[8:11], s33 offen sc1
s_waitcnt vmcnt(15)
v_add_u32 v11, 0x10000, v9
ds_write_b128 v11, v[200:203] offset:0
buffer_load_dwordx4 v[124:127], v2, s[8:11], s34 offen sc1
s_waitcnt vmcnt(15)
ds_write_b128 v11, v[204:207] offset:4096
buffer_load_dwordx4 v[128:131], v2, s[8:11], s35 offen sc1
s_waitcnt vmcnt(15)
ds_write_b128 v11, v[208:211] offset:8192
buffer_load_dwordx4 v[132:135], v2, s[8:11], s78 offen sc1
v_add_u32 v3, s83, v1
s_waitcnt vmcnt(15)
ds_write_b128 v11, v[212:215] offset:12288
buffer_load_dwordx4 v[136:139], v3, s[8:11], s32 offen sc1
s_waitcnt vmcnt(15)
buffer_load_dwordx4 v[140:143], v3, s[8:11], s33 offen sc1
s_waitcnt vmcnt(15)
buffer_load_dwordx4 v[144:147], v3, s[8:11], s34 offen sc1
s_waitcnt vmcnt(15)
buffer_load_dwordx4 v[148:151], v3, s[8:11], s35 offen sc1
s_waitcnt vmcnt(15)
buffer_load_dwordx4 v[152:155], v3, s[8:11], s78 offen sc1
v_add_u32 v2, s84, v1
s_waitcnt vmcnt(15)
buffer_load_dwordx4 v[156:159], v2, s[8:11], s32 offen sc1
s_waitcnt vmcnt(15)
buffer_load_dwordx4 v[160:163], v2, s[8:11], s33 offen sc1
s_waitcnt vmcnt(15)
buffer_load_dwordx4 v[164:167], v2, s[8:11], s34 offen sc1
s_waitcnt vmcnt(15)
buffer_load_dwordx4 v[168:171], v2, s[8:11], s35 offen sc1
s_waitcnt vmcnt(15)
buffer_load_dwordx4 v[172:175], v2, s[8:11], s78 offen sc1
v_add_u32 v3, s85, v1
s_waitcnt vmcnt(15)
buffer_load_dwordx4 v[176:179], v3, s[8:11], s32 offen sc1
s_waitcnt vmcnt(15)
buffer_load_dwordx4 v[180:183], v3, s[8:11], s33 offen sc1
s_waitcnt vmcnt(15)
buffer_load_dwordx4 v[184:187], v3, s[8:11], s34 offen sc1
s_waitcnt vmcnt(15)
buffer_load_dwordx4 v[188:191], v3, s[8:11], s35 offen sc1
s_waitcnt vmcnt(15)
buffer_load_dwordx4 v[192:195], v3, s[8:11], s78 offen sc1
s_branch L_g2pj_40
L_g2slow_39:
s_lshl_b32 s68, s3, 2
s_add_u32 s68, s68, s70
s_mul_i32 s79, s66, 1024
v_add_u32 v9, s79, v1
s_mul_i32 s71, s68, 196608
s_add_u32 s71, s71, s30
s_add_u32 s70, s66, 1
s_and_b32 s70, s70, 3
s_mul_i32 s70, s70, 49152
s_add_u32 s74, s71, s70
s_add_u32 s70, s66, 2
s_and_b32 s70, s70, 3
s_mul_i32 s70, s70, 49152
s_add_u32 s75, s71, s70
s_add_u32 s70, s66, 3
s_and_b32 s70, s70, 3
s_mul_i32 s70, s70, 49152
s_add_u32 s76, s71, s70
s_add_u32 s70, s66, 4
s_and_b32 s70, s70, 3
s_mul_i32 s70, s70, 49152
s_add_u32 s77, s71, s70
s_add_u32 s4, s64, 1048576
s_addc_u32 s5, s65, 0
s_mov_b32 s6, 6291456
s_mov_b32 s7, 0x20000
s_add_u32 s12, s64, 8388608
s_addc_u32 s13, s65, 0
s_mov_b32 s14, 2703360
s_mov_b32 s15, 0x20000
s_add_u32 s16, s64, 15728640
s_addc_u32 s17, s65, 0
s_mov_b32 s18, 16384
s_mov_b32 s19, 0x20000
s_mov_b32 s20, s60
s_mov_b32 s21, s61
s_mov_b32 s22, 2621440
s_mov_b32 s23, 0x20000
v_and_b32 v8, 15, v0
s_lshl_b32 s70, s68, 6
s_lshl_b32 s71, s66, 4
s_add_u32 s70, s70, s71
v_add_u32 v8, s70, v8
v_lshlrev_b32 v14, 3, v8
s_lshl_b32 s80, s31, 10
s_add_u32 s81, s31, 1
s_sub_u32 s73, s81, 12
s_cselect_b32 s81, s81, s73
s_lshl_b32 s81, s81, 10
s_add_u32 s82, s31, 2
s_sub_u32 s73, s82, 12
s_cselect_b32 s82, s82, s73
s_lshl_b32 s82, s82, 10
s_add_u32 s83, s31, 3
s_sub_u32 s73, s83, 12
s_cselect_b32 s83, s83, s73
s_lshl_b32 s83, s83, 10
s_add_u32 s84, s31, 4
s_sub_u32 s73, s84, 12
s_cselect_b32 s84, s84, s73
s_lshl_b32 s84, s84, 10
s_add_u32 s85, s31, 5
s_sub_u32 s73, s85, 12
s_cselect_b32 s85, s85, s73
s_lshl_b32 s85, s85, 10
s_add_u32 s86, s31, 6
s_sub_u32 s73, s86, 12
s_cselect_b32 s86, s86, s73
s_lshl_b32 s86, s86, 10
s_add_u32 s87, s31, 7
s_sub_u32 s73, s87, 12
s_cselect_b32 s87, s87, s73
s_lshl_b32 s87, s87, 10
s_add_u32 s88, s31, 8
s_sub_u32 s73, s88, 12
s_cselect_b32 s88, s88, s73
s_lshl_b32 s88, s88, 10
s_add_u32 s89, s31, 9
s_sub_u32 s73, s89, 12
s_cselect_b32 s89, s89, s73
s_lshl_b32 s89, s89, 10
s_add_u32 s90, s31, 10
s_sub_u32 s73, s90, 12
s_cselect_b32 s90, s90, s73
s_lshl_b32 s90, s90, 10
s_add_u32 s91, s31, 11
s_sub_u32 s73, s91, 12
s_cselect_b32 s91, s91, s73
s_lshl_b32 s91, s91, 10
v_add_u32 v2, s86, v1
buffer_load_dwordx4 v[16:19], v2, s[8:11], s32 offen sc1
buffer_load_dwordx4 v[20:23], v2, s[8:11], s33 offen sc1
buffer_load_dwordx4 v[24:27], v2, s[8:11], s34 offen sc1
s_waitcnt vmcnt(2)
s_barrier
s_cmp_eq_u32 s0, 0
s_cbranch_scc1 L_nopub_47
s_cmp_lg_u32 s66, 3
s_cbranch_scc1 L_pub_48
v_mov_b32 v5, s1
s_mov_b64 exec, 1
buffer_store_dword v5, v10, s[24:27], s0 offen sc1
s_mov_b64 exec, -1
L_pub_48:
L_nopub_47:
ds_write_b128 v9, v[16:19] offset:0
buffer_load_dwordx4 v[28:31], v2, s[8:11], s35 offen sc1
s_waitcnt vmcnt(2)
ds_write_b128 v9, v[20:23] offset:4096
buffer_load_dwordx4 v[32:35], v2, s[8:11], s78 offen sc1
v_add_u32 v3, s87, v1
s_waitcnt vmcnt(2)
ds_write_b128 v9, v[24:27] offset:8192
buffer_load_dwordx4 v[36:39], v3, s[8:11], s32 offen sc1
s_waitcnt vmcnt(2)
ds_write_b128 v9, v[28:31] offset:12288
buffer_load_dwordx4 v[40:43], v3, s[8:11], s33 offen sc1
s_waitcnt vmcnt(2)
ds_write_b128 v9, v[32:35] offset:16384
buffer_load_dwordx4 v[44:47], v3, s[8:11], s34 offen sc1
s_waitcnt vmcnt(2)
ds_write_b128 v9, v[36:39] offset:20480
buffer_load_dwordx4 v[48:51], v3, s[8:11], s35 offen sc1
s_waitcnt vmcnt(2)
ds_write_b128 v9, v[40:43] offset:24576
buffer_load_dwordx4 v[52:55], v3, s[8:11], s78 offen sc1
v_add_u32 v2, s88, v1
s_waitcnt vmcnt(2)
ds_write_b128 v9, v[44:47] offset:28672
buffer_load_dwordx4 v[56:59], v2, s[8:11], s32 offen sc1
s_waitcnt vmcnt(2)
ds_write_b128 v9, v[48:51] offset:32768
buffer_load_dwordx4 v[60:63], v2, s[8:11], s33 offen sc1
s_waitcnt vmcnt(2)
ds_write_b128 v9, v[52:55] offset:36864
buffer_load_dwordx4 v[64:67], v2, s[8:11], s34 offen sc1
s_waitcnt vmcnt(2)
ds_write_b128 v9, v[56:59] offset:40960
buffer_load_dwordx4 v[68:71], v2, s[8:11], s35 offen sc1
s_waitcnt vmcnt(2)
ds_write_b128 v9, v[60:63] offset:45056
buffer_load_dwordx4 v[72:75], v2, s[8:11], s78 offen sc1
v_add_u32 v3, s89, v1
s_waitcnt vmcnt(2)
ds_write_b128 v9, v[64:67] offset:49152
buffer_load_dwordx4 v[196:199], v3, s[8:11], s32 offen sc1
s_waitcnt vmcnt(2)
ds_write_b128 v9, v[68:71] offset:53248
buffer_load_dwordx4 v[200:203], v3, s[8:11], s33 offen sc1
s_waitcnt vmcnt(2)
ds_write_b128 v9, v[72:75] offset:57344
buffer_load_dwordx4 v[204:207], v3, s[8:11], s34 offen sc1
s_waitcnt vmcnt(2)
ds_write_b128 v9, v[196:199] offset:61440
buffer_load_dwordx4 v[208:211], v3, s[8:11], s35 offen sc1
s_waitcnt vmcnt(2)
v_add_u32 v11, 0x10000, v9
ds_write_b128 v11, v[200:203] offset:0
buffer_load_dwordx4 v[212:215], v3, s[8:11], s78 offen sc1
v_add_u32 v2, s80, v1
s_waitcnt vmcnt(2)
ds_write_b128 v11, v[204:207] offset:4096
buffer_load_dwordx4 v[76:79], v2, s[8:11], s32 offen sc1
s_waitcnt vmcnt(2)
ds_write_b128 v11, v[208:211] offset:8192
buffer_load_dwordx4 v[80:83], v2, s[8:11], s33 offen sc1
s_waitcnt vmcnt(2)
ds_write_b128 v11, v[212:215] offset:12288
buffer_load_dwordx4 v[84:87], v2, s[8:11], s34 offen sc1
s_waitcnt vmcnt(2)
buffer_load_dwordx4 v[88:91], v2, s[8:11], s35 offen sc1
s_waitcnt vmcnt(2)
buffer_load_dwordx4 v[92:95], v2, s[8:11], s78 offen sc1
v_add_u32 v3, s81, v1
s_waitcnt vmcnt(2)
buffer_load_dwordx4 v[96:99], v3, s[8:11], s32 offen sc1
s_waitcnt vmcnt(2)
buffer_load_dwordx4 v[100:103], v3, s[8:11], s33 offen sc1
s_waitcnt vmcnt(2)
buffer_load_dwordx4 v[104:107], v3, s[8:11], s34 offen sc1
s_waitcnt vmcnt(2)
buffer_load_dwordx4 v[108:111], v3, s[8:11], s35 offen sc1
s_waitcnt vmcnt(2)
buffer_load_dwordx4 v[112:115], v3, s[8:11], s78 offen sc1
v_add_u32 v2, s82, v1
s_waitcnt vmcnt(2)
buffer_load_dwordx4 v[116:119], v2, s[8:11], s32 offen sc1
s_waitcnt vmcnt(2)
buffer_load_dwordx4 v[120:123], v2, s[8:11], s33 offen sc1
s_waitcnt vmcnt(2)
buffer_load_dwordx4 v[124:127], v2, s[8:11], s34 offen sc1
s_waitcnt vmcnt(2)
buffer_load_dwordx4 v[128:131], v2, s[8:11], s35 offen sc1
s_waitcnt vmcnt(2)
buffer_load_dwordx4 v[132:135], v2, s[8:11], s78 offen sc1
v_add_u32 v3, s83, v1
s_waitcnt vmcnt(2)
buffer_load_dwordx4 v[136:139], v3, s[8:11], s32 offen sc1
s_waitcnt vmcnt(2)
buffer_load_dwordx4 v[140:143], v3, s[8:11], s33 offen sc1
s_waitcnt vmcnt(2)
buffer_load_dwordx4 v[144:147], v3, s[8:11], s34 offen sc1
s_waitcnt vmcnt(2)
buffer_load_dwordx4 v[148:151], v3, s[8:11], s35 offen sc1
s_waitcnt vmcnt(2)
buffer_load_dwordx4 v[152:155], v3, s[8:11], s78 offen sc1
v_add_u32 v2, s84, v1
s_waitcnt vmcnt(2)
buffer_load_dwordx4 v[156:159], v2, s[8:11], s32 offen sc1
s_waitcnt vmcnt(2)
buffer_load_dwordx4 v[160:163], v2, s[8:11], s33 offen sc1
s_waitcnt vmcnt(2)
buffer_load_dwordx4 v[164:167], v2, s[8:11], s34 offen sc1
s_waitcnt vmcnt(2)
buffer_load_dwordx4 v[168:171], v2, s[8:11], s35 offen sc1
s_waitcnt vmcnt(2)
buffer_load_dwordx4 v[172:175], v2, s[8:11], s78 offen sc1
v_add_u32 v3, s85, v1
s_waitcnt vmcnt(2)
buffer_load_dwordx4 v[176:179], v3, s[8:11], s32 offen sc1
s_waitcnt vmcnt(2)
buffer_load_dwordx4 v[180:183], v3, s[8:11], s33 offen sc1
s_waitcnt vmcnt(2)
buffer_load_dwordx4 v[184:187], v3, s[8:11], s34 offen sc1
s_waitcnt vmcnt(2)
buffer_load_dwordx4 v[188:191], v3, s[8:11], s35 offen sc1
s_waitcnt vmcnt(2)
buffer_load_dwordx4 v[192:195], v3, s[8:11], s78 offen sc1
L_g2pj_40:
s_and_b32 s70, s68, 7
s_lshl_b32 s70, s70, 2
s_bitcmp1_b32 s68, 3
s_mov_b32 s71, 554762240
s_cmov_b32 s71, 1145254690
s_mov_b32 s72, 554766336
s_cmov_b32 s72, 1145254690
s_lshr_b32 s71, s71, s70
s_lshr_b32 s72, s72, s70
s_and_b32 s71, s71, 15
s_and_b32 s72, s72, 15
s_lshr_b32 s70, s68, 4
s_mul_i32 s70, s70, 5
s_add_u32 s71, s71, s70
s_add_u32 s72, s72, s70
s_mul_i32 s71, s71, 3072
s_mul_i32 s72, s72, 3072
v_mov_b32 v11, s71
v_mov_b32 v12, s72
v_cmp_gt_u32 vcc, 32, v0
s_nop 1
v_cndmask_b32 v11, v12, v11, vcc
v_and_b32 v12, 31, v0
v_min_u32 v12, 23, v12
v_lshl_add_u32 v4, v12, 7, v11
v_add_u32 v4, 24576, v4
v_lshrrev_b32 v11, 3, v0
v_and_b32 v12, 7, v0
v_mul_u32_u24 v6, 128, v11
v_lshl_add_u32 v6, v12, 4, v6
s_add_u32 s70, s79, 61440
v_add_u32 v6, s70, v6
s_lshl_b32 s70, s66, 3
v_add_u32 v11, s70, v11
v_mul_u32_u24 v7, 4224, v11
v_lshl_add_u32 v7, v12, 4, v7
v_min_u32 v13, 19, v0
s_mul_i32 s70, s69, 2560
s_add_u32 s70, s70, 55296
v_lshl_add_u32 v13, v13, 7, s70
s_lshr_b32 s70, s68, 1
s_lshl_b32 s70, s70, 7
s_add_u32 s70, s70, 4096
v_mov_b32 v12, s70
v_cmp_gt_u32 vcc, 20, v0
s_nop 1
v_cndmask_b32 v13, v12, v13, vcc
s_mul_i32 s70, s69, 337920
s_lshl_b32 s71, s68, 7
s_add_u32 s70, s70, s71
s_add_u32 s71, s70, 135168
s_add_u32 s72, s70, 270336
s_cmp_ge_u32 s66, 2
s_cselect_b32 s72, 0x8000000, s72
v_not_b32 v15, s1
L_g2pk_41:
s_waitcnt lgkmcnt(0)
v_add_u32 v11, 0x10000, v9
s_cmp_lg_u32 s66, 0
s_cbranch_scc1 L_g2nw_49
s_waitcnt vmcnt(6)
s_mov_b32 s73, 10791
v_cmp_ne_u32 vcc, s1, v15
s_cbranch_vccz L_pollok_51
L_poll_50:
buffer_load_dword v15, v4, s[24:27], 0 offen sc1
s_waitcnt vmcnt(0)
v_cmp_ne_u32 vcc, s1, v15
s_cbranch_vccz L_pollok_51
s_sleep 8
s_sub_u32 s73, s73, 1
s_cbranch_scc0 L_poll_50
L_pollok_51:
L_g2nw_49:
s_barrier
v_add_u32 v2, s80, v1
buffer_load_dwordx4 v[196:199], v2, s[4:7], s74 offen sc1
buffer_load_dwordx4 v[200:203], v2, s[4:7], s75 offen sc1
buffer_load_dwordx4 v[204:207], v2, s[4:7], s76 offen sc1
buffer_load_dwordx4 v[208:211], v2, s[4:7], s77 offen sc1
v_add_u32 v3, s81, v1
buffer_load_dwordx4 v[212:215], v3, s[4:7], s74 offen sc1
buffer_load_dwordx4 v[216:219], v3, s[4:7], s75 offen sc1
buffer_load_dwordx4 v[220:223], v3, s[4:7], s76 offen sc1
buffer_load_dwordx4 v[224:227], v3, s[4:7], s77 offen sc1
v_add_u32 v2, s82, v1
buffer_load_dwordx4 v[228:231], v2, s[4:7], s74 offen sc1
buffer_load_dwordx4 v[232:235], v2, s[4:7], s75 offen sc1
buffer_load_dwordx4 v[236:239], v2, s[4:7], s76 offen sc1
buffer_load_dwordx4 v[240:243], v2, s[4:7], s77 offen sc1
s_waitcnt vmcnt(11)
v_mfma_f32_16x16x32_bf16 v[16:19], v[76:79], v[196:199], 0
v_mfma_f32_16x16x32_bf16 v[20:23], v[80:83], v[196:199], 0
v_mfma_f32_16x16x32_bf16 v[24:27], v[84:87], v[196:199], 0
v_mfma_f32_16x16x32_bf16 v[28:31], v[88:91], v[196:199], 0
v_add_u32 v4, s83, v1
v_mfma_f32_16x16x32_bf16 v[32:35], v[92:95], v[196:199], 0
buffer_load_dwordx4 v[196:199], v4, s[4:7], s74 offen sc1
s_waitcnt vmcnt(11)
v_mfma_f32_16x16x32_bf16 v[36:39], v[76:79], v[200:203], 0
v_mfma_f32_16x16x32_bf16 v[40:43], v[80:83], v[200:203], 0
v_mfma_f32_16x16x32_bf16 v[44:47], v[84:87], v[200:203], 0
v_mfma_f32_16x16x32_bf16 v[48:51], v[88:91], v[200:203], 0
v_mfma_f32_16x16x32_bf16 v[52:55], v[92:95], v[200:203], 0
buffer_load_dwordx4 v[200:203], v4, s[4:7], s75 offen sc1
s_waitcnt vmcnt(11)
v_mfma_f32_16x16x32_bf16 v[56:59], v[76:79], v[204:207], 0
v_mfma_f32_16x16x32_bf16 v[60:63], v[80:83], v[204:207], 0
v_mfma_f32_16x16x32_bf16 v[64:67], v[84:87], v[204:207], 0
v_mfma_f32_16x16x32_bf16 v[68:71], v[88:91], v[204:207], 0
v_mfma_f32_16x16x32_bf16 v[72:75], v[92:95], v[204:207], 0
buffer_load_dwordx4 v[204:207], v4, s[4:7], s76 offen sc1
s_waitcnt vmcnt(11)
v_mfma_f32_16x16x32_bf16 v[76:79], v[76:79], v[208:211], 0
v_mfma_f32_16x16x32_bf16 v[80:83], v[80:83], v[208:211], 0
v_mfma_f32_16x16x32_bf16 v[84:87], v[84:87], v[208:211], 0
v_mfma_f32_16x16x32_bf16 v[88:91], v[88:91], v[208:211], 0
v_mfma_f32_16x16x32_bf16 v[92:95], v[92:95], v[208:211], 0
buffer_load_dwordx4 v[208:211], v4, s[4:7], s77 offen sc1
s_waitcnt vmcnt(11)
v_mfma_f32_16x16x32_bf16 v[16:19], v[96:99], v[212:215], v[16:19]
v_mfma_f32_16x16x32_bf16 v[20:23], v[100:103], v[212:215], v[20:23]
v_mfma_f32_16x16x32_bf16 v[24:27], v[104:107], v[212:215], v[24:27]
v_mfma_f32_16x16x32_bf16 v[28:31], v[108:111], v[212:215], v[28:31]
v_add_u32 v4, s84, v1
v_mfma_f32_16x16x32_bf16 v[32:35], v[112:115], v[212:215], v[32:35]
buffer_load_dwordx4 v[212:215], v4, s[4:7], s74 offen sc1
s_waitcnt vmcnt(11)
v_mfma_f32_16x16x32_bf16 v[36:39], v[96:99], v[216:219], v[36:39]
v_mfma_f32_16x16x32_bf16 v[40:43], v[100:103], v[216:219], v[40:43]
v_mfma_f32_16x16x32_bf16 v[44:47], v[104:107], v[216:219], v[44:47]
v_mfma_f32_16x16x32_bf16 v[48:51], v[108:111], v[216:219], v[48:51]
v_mfma_f32_16x16x32_bf16 v[52:55], v[112:115], v[216:219], v[52:55]
buffer_load_dwordx4 v[216:219], v4, s[4:7], s75 offen sc1
s_waitcnt vmcnt(11)
v_mfma_f32_16x16x32_bf16 v[56:59], v[96:99], v[220:223], v[56:59]
v_mfma_f32_16x16x32_bf16 v[60:63], v[100:103], v[220:223], v[60:63]
v_mfma_f32_16x16x32_bf16 v[64:67], v[104:107], v[220:223], v[64:67]
v_mfma_f32_16x16x32_bf16 v[68:71], v[108:111], v[220:223], v[68:71]
v_mfma_f32_16x16x32_bf16 v[72:75], v[112:115], v[220:223], v[72:75]
buffer_load_dwordx4 v[220:223], v4, s[4:7], s76 offen sc1
s_waitcnt vmcnt(11)
v_mfma_f32_16x16x32_bf16 v[76:79], v[96:99], v[224:227], v[76:79]
v_mfma_f32_16x16x32_bf16 v[80:83], v[100:103], v[224:227], v[80:83]
v_mfma_f32_16x16x32_bf16 v[84:87], v[104:107], v[224:227], v[84:87]
v_mfma_f32_16x16x32_bf16 v[88:91], v[108:111], v[224:227], v[88:91]
v_mfma_f32_16x16x32_bf16 v[92:95], v[112:115], v[224:227], v[92:95]
buffer_load_dwordx4 v[224:227], v4, s[4:7], s77 offen sc1
s_waitcnt vmcnt(11)
v_mfma_f32_16x16x32_bf16 v[16:19], v[116:119], v[228:231], v[16:19]
v_mfma_f32_16x16x32_bf16 v[20:23], v[120:123], v[228:231], v[20:23]
v_mfma_f32_16x16x32_bf16 v[24:27], v[124:127], v[228:231], v[24:27]
v_mfma_f32_16x16x32_bf16 v[28:31], v[128:131], v[228:231], v[28:31]
v_add_u32 v4, s85, v1
v_mfma_f32_16x16x32_bf16 v[32:35], v[132:135], v[228:231], v[32:35]
buffer_load_dwordx4 v[228:231], v4, s[4:7], s74 offen sc1
s_waitcnt vmcnt(11)
v_mfma_f32_16x16x32_bf16 v[36:39], v[116:119], v[232:235], v[36:39]
v_mfma_f32_16x16x32_bf16 v[40:43], v[120:123], v[232:235], v[40:43]
v_mfma_f32_16x16x32_bf16 v[44:47], v[124:127], v[232:235], v[44:47]
v_mfma_f32_16x16x32_bf16 v[48:51], v[128:131], v[232:235], v[48:51]
v_mfma_f32_16x16x32_bf16 v[52:55], v[132:135], v[232:235], v[52:55]
buffer_load_dwordx4 v[232:235], v4, s[4:7], s75 offen sc1
s_waitcnt vmcnt(11)
v_mfma_f32_16x16x32_bf16 v[56:59], v[116:119], v[236:239], v[56:59]
v_mfma_f32_16x16x32_bf16 v[60:63], v[120:123], v[236:239], v[60:63]
v_mfma_f32_16x16x32_bf16 v[64:67], v[124:127], v[236:239], v[64:67]
v_mfma_f32_16x16x32_bf16 v[68:71], v[128:131], v[236:239], v[68:71]
v_mfma_f32_16x16x32_bf16 v[72:75], v[132:135], v[236:239], v[72:75]
buffer_load_dwordx4 v[236:239], v4, s[4:7], s76 offen sc1
s_waitcnt vmcnt(11)
v_mfma_f32_16x16x32_bf16 v[76:79], v[116:119], v[240:243], v[76:79]
v_mfma_f32_16x16x32_bf16 v[80:83], v[120:123], v[240:243], v[80:83]
v_mfma_f32_16x16x32_bf16 v[84:87], v[124:127], v[240:243], v[84:87]
v_mfma_f32_16x16x32_bf16 v[88:91], v[128:131], v[240:243], v[88:91]
v_mfma_f32_16x16x32_bf16 v[92:95], v[132:135], v[240:243], v[92:95]
buffer_load_dwordx4 v[240:243], v4, s[4:7], s77 offen sc1
s_waitcnt vmcnt(11)
v_mfma_f32_16x16x32_bf16 v[16:19], v[136:139], v[196:199], v[16:19]
v_mfma_f32_16x16x32_bf16 v[20:23], v[140:143], v[196:199], v[20:23]
v_mfma_f32_16x16x32_bf16 v[24:27], v[144:147], v[196:199], v[24:27]
v_mfma_f32_16x16x32_bf16 v[28:31], v[148:151], v[196:199], v[28:31]
v_add_u32 v4, s86, v1
v_mfma_f32_16x16x32_bf16 v[32:35], v[152:155], v[196:199], v[32:35]
buffer_load_dwordx4 v[196:199], v4, s[4:7], s74 offen sc1
s_waitcnt vmcnt(11)
v_mfma_f32_16x16x32_bf16 v[36:39], v[136:139], v[200:203], v[36:39]
v_mfma_f32_16x16x32_bf16 v[40:43], v[140:143], v[200:203], v[40:43]
v_mfma_f32_16x16x32_bf16 v[44:47], v[144:147], v[200:203], v[44:47]
v_mfma_f32_16x16x32_bf16 v[48:51], v[148:151], v[200:203], v[48:51]
v_mfma_f32_16x16x32_bf16 v[52:55], v[152:155], v[200:203], v[52:55]
buffer_load_dwordx4 v[200:203], v4, s[4:7], s75 offen sc1
s_waitcnt vmcnt(11)
v_mfma_f32_16x16x32_bf16 v[56:59], v[136:139], v[204:207], v[56:59]
v_mfma_f32_16x16x32_bf16 v[60:63], v[140:143], v[204:207], v[60:63]
v_mfma_f32_16x16x32_bf16 v[64:67], v[144:147], v[204:207], v[64:67]
v_mfma_f32_16x16x32_bf16 v[68:71], v[148:151], v[204:207], v[68:71]
v_mfma_f32_16x16x32_bf16 v[72:75], v[152:155], v[204:207], v[72:75]
buffer_load_dwordx4 v[204:207], v4, s[4:7], s76 offen sc1
s_waitcnt vmcnt(11)
v_mfma_f32_16x16x32_bf16 v[76:79], v[136:139], v[208:211], v[76:79]
v_mfma_f32_16x16x32_bf16 v[80:83], v[140:143], v[208:211], v[80:83]
v_mfma_f32_16x16x32_bf16 v[84:87], v[144:147], v[208:211], v[84:87]
v_mfma_f32_16x16x32_bf16 v[88:91], v[148:151], v[208:211], v[88:91]
v_mfma_f32_16x16x32_bf16 v[92:95], v[152:155], v[208:211], v[92:95]
buffer_load_dwordx4 v[208:211], v4, s[4:7], s77 offen sc1
s_waitcnt vmcnt(11)
v_mfma_f32_16x16x32_bf16 v[16:19], v[156:159], v[212:215], v[16:19]
v_mfma_f32_16x16x32_bf16 v[20:23], v[160:163], v[212:215], v[20:23]
ds_read_b128 v[136:139], v9 offset:0
v_mfma_f32_16x16x32_bf16 v[24:27], v[164:167], v[212:215], v[24:27]
v_mfma_f32_16x16x32_bf16 v[28:31], v[168:171], v[212:215], v[28:31]
v_add_u32 v4, s87, v1
v_mfma_f32_16x16x32_bf16 v[32:35], v[172:175], v[212:215], v[32:35]
ds_read_b128 v[140:143], v9 offset:4096
buffer_load_dwordx4 v[212:215], v4, s[4:7], s74 offen sc1
s_waitcnt vmcnt(11)
v_mfma_f32_16x16x32_bf16 v[36:39], v[156:159], v[216:219], v[36:39]
v_mfma_f32_16x16x32_bf16 v[40:43], v[160:163], v[216:219], v[40:43]
v_mfma_f32_16x16x32_bf16 v[44:47], v[164:167], v[216:219], v[44:47]
ds_read_b128 v[144:147], v9 offset:8192
v_mfma_f32_16x16x32_bf16 v[48:51], v[168:171], v[216:219], v[48:51]
v_mfma_f32_16x16x32_bf16 v[52:55], v[172:175], v[216:219], v[52:55]
buffer_load_dwordx4 v[216:219], v4, s[4:7], s75 offen sc1
s_waitcnt vmcnt(11)
v_mfma_f32_16x16x32_bf16 v[56:59], v[156:159], v[220:223], v[56:59]
ds_read_b128 v[148:151], v9 offset:12288
v_mfma_f32_16x16x32_bf16 v[60:63], v[160:163], v[220:223], v[60:63]
v_mfma_f32_16x16x32_bf16 v[64:67], v[164:167], v[220:223], v[64:67]
v_mfma_f32_16x16x32_bf16 v[68:71], v[168:171], v[220:223], v[68:71]
ds_read_b128 v[152:155], v9 offset:16384
v_mfma_f32_16x16x32_bf16 v[72:75], v[172:175], v[220:223], v[72:75]
buffer_load_dwordx4 v[220:223], v4, s[4:7], s76 offen sc1
s_waitcnt vmcnt(11)
v_mfma_f32_16x16x32_bf16 v[76:79], v[156:159], v[224:227], v[76:79]
v_mfma_f32_16x16x32_bf16 v[80:83], v[160:163], v[224:227], v[80:83]
v_mfma_f32_16x16x32_bf16 v[84:87], v[164:167], v[224:227], v[84:87]
v_mfma_f32_16x16x32_bf16 v[88:91], v[168:171], v[224:227], v[88:91]
v_mfma_f32_16x16x32_bf16 v[92:95], v[172:175], v[224:227], v[92:95]
buffer_load_dwordx4 v[224:227], v4, s[4:7], s77 offen sc1
s_waitcnt vmcnt(11)
v_mfma_f32_16x16x32_bf16 v[16:19], v[176:179], v[228:231], v[16:19]
v_mfma_f32_16x16x32_bf16 v[20:23], v[180:183], v[228:231], v[20:23]
ds_read_b128 v[156:159], v9 offset:20480
v_mfma_f32_16x16x32_bf16 v[24:27], v[184:187], v[228:231], v[24:27]
v_mfma_f32_16x16x32_bf16 v[28:31], v[188:191], v[228:231], v[28:31]
v_add_u32 v4, s88, v1
v_mfma_f32_16x16x32_bf16 v[32:35], v[192:195], v[228:231], v[32:35]
ds_read_b128 v[160:163], v9 offset:24576
buffer_load_dwordx4 v[228:231], v4, s[4:7], s74 offen sc1
s_waitcnt vmcnt(11)
v_mfma_f32_16x16x32_bf16 v[36:39], v[176:179], v[232:235], v[36:39]
v_mfma_f32_16x16x32_bf16 v[40:43], v[180:183], v[232:235], v[40:43]
v_mfma_f32_16x16x32_bf16 v[44:47], v[184:187], v[232:235], v[44:47]
ds_read_b128 v[164:167], v9 offset:28672
v_mfma_f32_16x16x32_bf16 v[48:51], v[188:191], v[232:235], v[48:51]
v_mfma_f32_16x16x32_bf16 v[52:55], v[192:195], v[232:235], v[52:55]
buffer_load_dwordx4 v[232:235], v4, s[4:7], s75 offen sc1
s_waitcnt vmcnt(11)
v_mfma_f32_16x16x32_bf16 v[56:59], v[176:179], v[236:239], v[56:59]
ds_read_b128 v[168:171], v9 offset:32768
v_mfma_f32_16x16x32_bf16 v[60:63], v[180:183], v[236:239], v[60:63]
v_mfma_f32_16x16x32_bf16 v[64:67], v[184:187], v[236:239], v[64:67]
v_mfma_f32_16x16x32_bf16 v[68:71], v[188:191], v[236:239], v[68:71]
ds_read_b128 v[172:175], v9 offset:36864
v_mfma_f32_16x16x32_bf16 v[72:75], v[192:195], v[236:239], v[72:75]
buffer_load_dwordx4 v[236:239], v4, s[4:7], s76 offen sc1
s_waitcnt vmcnt(11)
v_mfma_f32_16x16x32_bf16 v[76:79], v[176:179], v[240:243], v[76:79]
v_mfma_f32_16x16x32_bf16 v[80:83], v[180:183], v[240:243], v[80:83]
v_mfma_f32_16x16x32_bf16 v[84:87], v[184:187], v[240:243], v[84:87]
v_mfma_f32_16x16x32_bf16 v[88:91], v[188:191], v[240:243], v[88:91]
v_mfma_f32_16x16x32_bf16 v[92:95], v[192:195], v[240:243], v[92:95]
buffer_load_dwordx4 v[240:243], v4, s[4:7], s77 offen sc1
s_waitcnt vmcnt(11) lgkmcnt(5)
v_mfma_f32_16x16x32_bf16 v[16:19], v[136:139], v[196:199], v[16:19]
v_add_u32 v3, s90, v1
v_mfma_f32_16x16x32_bf16 v[20:23], v[140:143], v[196:199], v[20:23]
buffer_load_dwordx4 v[96:99], v3, s[8:11], s32 offen sc1
ds_read_b128 v[176:179], v9 offset:40960
v_mfma_f32_16x16x32_bf16 v[24:27], v[144:147], v[196:199], v[24:27]
v_mfma_f32_16x16x32_bf16 v[28:31], v[148:151], v[196:199], v[28:31]
v_add_u32 v4, s89, v1
v_mfma_f32_16x16x32_bf16 v[32:35], v[152:155], v[196:199], v[32:35]
buffer_load_dwordx4 v[100:103], v3, s[8:11], s33 offen sc1
ds_read_b128 v[180:183], v9 offset:45056
buffer_load_dwordx4 v[196:199], v4, s[4:7], s74 offen sc1
s_waitcnt vmcnt(13)
v_mfma_f32_16x16x32_bf16 v[36:39], v[136:139], v[200:203], v[36:39]
v_mfma_f32_16x16x32_bf16 v[40:43], v[140:143], v[200:203], v[40:43]
v_mfma_f32_16x16x32_bf16 v[44:47], v[144:147], v[200:203], v[44:47]
buffer_load_dwordx4 v[104:107], v3, s[8:11], s34 offen sc1
ds_read_b128 v[184:187], v9 offset:49152
v_mfma_f32_16x16x32_bf16 v[48:51], v[148:151], v[200:203], v[48:51]
v_mfma_f32_16x16x32_bf16 v[52:55], v[152:155], v[200:203], v[52:55]
buffer_load_dwordx4 v[200:203], v4, s[4:7], s75 offen sc1
s_waitcnt vmcnt(14)
v_mfma_f32_16x16x32_bf16 v[56:59], v[136:139], v[204:207], v[56:59]
buffer_load_dwordx4 v[108:111], v3, s[8:11], s35 offen sc1
ds_read_b128 v[188:191], v9 offset:53248
v_mfma_f32_16x16x32_bf16 v[60:63], v[140:143], v[204:207], v[60:63]
v_mfma_f32_16x16x32_bf16 v[64:67], v[144:147], v[204:207], v[64:67]
v_mfma_f32_16x16x32_bf16 v[68:71], v[148:151], v[204:207], v[68:71]
buffer_load_dwordx4 v[112:115], v3, s[8:11], s78 offen sc1
ds_read_b128 v[192:195], v9 offset:57344
v_mfma_f32_16x16x32_bf16 v[72:75], v[152:155], v[204:207], v[72:75]
buffer_load_dwordx4 v[204:207], v4, s[4:7], s76 offen sc1
s_waitcnt vmcnt(16)
v_mfma_f32_16x16x32_bf16 v[76:79], v[136:139], v[208:211], v[76:79]
v_mfma_f32_16x16x32_bf16 v[80:83], v[140:143], v[208:211], v[80:83]
v_mfma_f32_16x16x32_bf16 v[84:87], v[144:147], v[208:211], v[84:87]
v_mfma_f32_16x16x32_bf16 v[88:91], v[148:151], v[208:211], v[88:91]
v_mfma_f32_16x16x32_bf16 v[92:95], v[152:155], v[208:211], v[92:95]
buffer_load_dwordx4 v[208:211], v4, s[4:7], s77 offen sc1
s_waitcnt vmcnt(16) lgkmcnt(5)
v_mfma_f32_16x16x32_bf16 v[16:19], v[156:159], v[212:215], v[16:19]
v_add_u32 v2, s91, v1
v_mfma_f32_16x16x32_bf16 v[20:23], v[160:163], v[212:215], v[20:23]
buffer_load_dwordx4 v[116:119], v2, s[8:11], s32 offen sc1
ds_read_b128 v[136:139], v9 offset:61440
v_mfma_f32_16x16x32_bf16 v[24:27], v[164:167], v[212:215], v[24:27]
v_mfma_f32_16x16x32_bf16 v[28:31], v[168:171], v[212:215], v[28:31]
v_add_u32 v4, s90, v1
v_mfma_f32_16x16x32_bf16 v[32:35], v[172:175], v[212:215], v[32:35]
buffer_load_dwordx4 v[120:123], v2, s[8:11], s33 offen sc1
ds_read_b128 v[140:143], v11 offset:0
buffer_load_dwordx4 v[212:215], v4, s[4:7], s74 offen sc1
s_waitcnt vmcnt(18)
v_mfma_f32_16x16x32_bf16 v[36:39], v[156:159], v[216:219], v[36:39]
v_mfma_f32_16x16x32_bf16 v[40:43], v[160:163], v[216:219], v[40:43]
v_mfma_f32_16x16x32_bf16 v[44:47], v[164:167], v[216:219], v[44:47]
buffer_load_dwordx4 v[124:127], v2, s[8:11], s34 offen sc1
ds_read_b128 v[144:147], v11 offset:4096
v_mfma_f32_16x16x32_bf16 v[48:51], v[168:171], v[216:219], v[48:51]
v_mfma_f32_16x16x32_bf16 v[52:55], v[172:175], v[216:219], v[52:55]
buffer_load_dwordx4 v[216:219], v4, s[4:7], s75 offen sc1
s_waitcnt vmcnt(19)
v_mfma_f32_16x16x32_bf16 v[56:59], v[156:159], v[220:223], v[56:59]
buffer_load_dwordx4 v[128:131], v2, s[8:11], s35 offen sc1
ds_read_b128 v[148:151], v11 offset:8192
v_mfma_f32_16x16x32_bf16 v[60:63], v[160:163], v[220:223], v[60:63]
v_mfma_f32_16x16x32_bf16 v[64:67], v[164:167], v[220:223], v[64:67]
v_mfma_f32_16x16x32_bf16 v[68:71], v[168:171], v[220:223], v[68:71]
buffer_load_dwordx4 v[132:135], v2, s[8:11], s78 offen sc1
ds_read_b128 v[152:155], v11 offset:12288
v_mfma_f32_16x16x32_bf16 v[72:75], v[172:175], v[220:223], v[72:75]
buffer_load_dwordx4 v[220:223], v4, s[4:7], s76 offen sc1
s_waitcnt vmcnt(21)
v_mfma_f32_16x16x32_bf16 v[76:79], v[156:159], v[224:227], v[76:79]
v_mfma_f32_16x16x32_bf16 v[80:83], v[160:163], v[224:227], v[80:83]
v_mfma_f32_16x16x32_bf16 v[84:87], v[164:167], v[224:227], v[84:87]
v_mfma_f32_16x16x32_bf16 v[88:91], v[168:171], v[224:227], v[88:91]
v_mfma_f32_16x16x32_bf16 v[92:95], v[172:175], v[224:227], v[92:95]
buffer_load_dwordx4 v[224:227], v4, s[4:7], s77 offen sc1
buffer_load_dword v12, v13, s[24:27], 0 offen sc1
s_waitcnt vmcnt(22) lgkmcnt(5)
v_mfma_f32_16x16x32_bf16 v[16:19], v[176:179], v[228:231], v[16:19]
v_mfma_f32_16x16x32_bf16 v[20:23], v[180:183], v[228:231], v[20:23]
v_mfma_f32_16x16x32_bf16 v[24:27], v[184:187], v[228:231], v[24:27]
v_mfma_f32_16x16x32_bf16 v[28:31], v[188:191], v[228:231], v[28:31]
v_add_u32 v4, s91, v1
v_mfma_f32_16x16x32_bf16 v[32:35], v[192:195], v[228:231], v[32:35]
buffer_load_dwordx4 v[228:231], v4, s[4:7], s74 offen sc1
s_waitcnt vmcnt(22)
v_mfma_f32_16x16x32_bf16 v[36:39], v[176:179], v[232:235], v[36:39]
v_mfma_f32_16x16x32_bf16 v[40:43], v[180:183], v[232:235], v[40:43]
v_mfma_f32_16x16x32_bf16 v[44:47], v[184:187], v[232:235], v[44:47]
v_mfma_f32_16x16x32_bf16 v[48:51], v[188:191], v[232:235], v[48:51]
v_mfma_f32_16x16x32_bf16 v[52:55], v[192:195], v[232:235], v[52:55]
buffer_load_dwordx4 v[232:235], v4, s[4:7], s75 offen sc1
s_waitcnt vmcnt(22)
v_mfma_f32_16x16x32_bf16 v[56:59], v[176:179], v[236:239], v[56:59]
v_mfma_f32_16x16x32_bf16 v[60:63], v[180:183], v[236:239], v[60:63]
v_mfma_f32_16x16x32_bf16 v[64:67], v[184:187], v[236:239], v[64:67]
v_mfma_f32_16x16x32_bf16 v[68:71], v[188:191], v[236:239], v[68:71]
v_mfma_f32_16x16x32_bf16 v[72:75], v[192:195], v[236:239], v[72:75]
buffer_load_dwordx4 v[236:239], v4, s[4:7], s76 offen sc1
s_waitcnt vmcnt(22)
v_mfma_f32_16x16x32_bf16 v[76:79], v[176:179], v[240:243], v[76:79]
v_mfma_f32_16x16x32_bf16 v[80:83], v[180:183], v[240:243], v[80:83]
v_mfma_f32_16x16x32_bf16 v[84:87], v[184:187], v[240:243], v[84:87]
v_mfma_f32_16x16x32_bf16 v[88:91], v[188:191], v[240:243], v[88:91]
v_mfma_f32_16x16x32_bf16 v[92:95], v[192:195], v[240:243], v[92:95]
buffer_load_dwordx4 v[240:243], v4, s[4:7], s77 offen sc1
s_waitcnt vmcnt(4)
v_cmp_ne_u32 vcc, s1, v12
s_nop 0
s_cmp_eq_u64 vcc, 0
s_cselect_b32 s30, 0, 0x8000000
s_add_u32 s28, s70, s30
s_add_u32 s29, s71, s30
s_add_u32 s31, s72, s30
buffer_load_dwordx2 v[14:15], v14, s[16:19], s30 offen sc1
buffer_load_dwordx4 v[244:247], v7, s[12:15], s28 offen sc1
buffer_load_dwordx4 v[248:251], v7, s[12:15], s29 offen sc1
buffer_load_dwordx4 v[252:255], v7, s[12:15], s31 offen sc1
s_waitcnt lgkmcnt(0)
s_waitcnt vmcnt(24)
v_mfma_f32_16x16x32_bf16 v[16:19], v[136:139], v[196:199], v[16:19]
v_mfma_f32_16x16x32_bf16 v[20:23], v[140:143], v[196:199], v[20:23]
v_mfma_f32_16x16x32_bf16 v[24:27], v[144:147], v[196:199], v[24:27]
v_mfma_f32_16x16x32_bf16 v[28:31], v[148:151], v[196:199], v[28:31]
v_mfma_f32_16x16x32_bf16 v[32:35], v[152:155], v[196:199], v[32:35]
s_waitcnt vmcnt(15)
v_mfma_f32_16x16x32_bf16 v[16:19], v[96:99], v[212:215], v[16:19]
v_mfma_f32_16x16x32_bf16 v[20:23], v[100:103], v[212:215], v[20:23]
v_mfma_f32_16x16x32_bf16 v[24:27], v[104:107], v[212:215], v[24:27]
v_mfma_f32_16x16x32_bf16 v[28:31], v[108:111], v[212:215], v[28:31]
v_mfma_f32_16x16x32_bf16 v[32:35], v[112:115], v[212:215], v[32:35]
s_waitcnt vmcnt(7)
v_mfma_f32_16x16x32_bf16 v[16:19], v[116:119], v[228:231], v[16:19]
v_mfma_f32_16x16x32_bf16 v[20:23], v[120:123], v[228:231], v[20:23]
v_mfma_f32_16x16x32_bf16 v[24:27], v[124:127], v[228:231], v[24:27]
v_mfma_f32_16x16x32_bf16 v[28:31], v[128:131], v[228:231], v[28:31]
v_mfma_f32_16x16x32_bf16 v[32:35], v[132:135], v[228:231], v[32:35]
s_waitcnt vmcnt(22)
v_mfma_f32_16x16x32_bf16 v[36:39], v[136:139], v[200:203], v[36:39]
v_mfma_f32_16x16x32_bf16 v[40:43], v[140:143], v[200:203], v[40:43]
v_mfma_f32_16x16x32_bf16 v[44:47], v[144:147], v[200:203], v[44:47]
ds_write_b128 v9, v[16:19] offset:0
v_mfma_f32_16x16x32_bf16 v[48:51], v[148:151], v[200:203], v[48:51]
v_mfma_f32_16x16x32_bf16 v[52:55], v[152:155], v[200:203], v[52:55]
ds_write_b128 v9, v[20:23] offset:4096
s_waitcnt vmcnt(13)
v_mfma_f32_16x16x32_bf16 v[36:39], v[96:99], v[216:219], v[36:39]
v_mfma_f32_16x16x32_bf16 v[40:43], v[100:103], v[216:219], v[40:43]
ds_write_b128 v9, v[24:27] offset:8192
v_mfma_f32_16x16x32_bf16 v[44:47], v[104:107], v[216:219], v[44:47]
v_mfma_f32_16x16x32_bf16 v[48:51], v[108:111], v[216:219], v[48:51]
ds_write_b128 v9, v[28:31] offset:12288
v_mfma_f32_16x16x32_bf16 v[52:55], v[112:115], v[216:219], v[52:55]
s_waitcnt vmcnt(6)
v_mfma_f32_16x16x32_bf16 v[36:39], v[116:119], v[232:235], v[36:39]
ds_write_b128 v9, v[32:35] offset:16384
v_mfma_f32_16x16x32_bf16 v[40:43], v[120:123], v[232:235], v[40:43]
v_mfma_f32_16x16x32_bf16 v[44:47], v[124:127], v[232:235], v[44:47]
v_mfma_f32_16x16x32_bf16 v[48:51], v[128:131], v[232:235], v[48:51]
v_mfma_f32_16x16x32_bf16 v[52:55], v[132:135], v[232:235], v[52:55]
s_waitcnt vmcnt(19)
v_mfma_f32_16x16x32_bf16 v[56:59], v[136:139], v[204:207], v[56:59]
v_mfma_f32_16x16x32_bf16 v[60:63], v[140:143], v[204:207], v[60:63]
v_mfma_f32_16x16x32_bf16 v[64:67], v[144:147], v[204:207], v[64:67]
ds_write_b128 v9, v[36:39] offset:20480
v_mfma_f32_16x16x32_bf16 v[68:71], v[148:151], v[204:207], v[68:71]
v_mfma_f32_16x16x32_bf16 v[72:75], v[152:155], v[204:207], v[72:75]
ds_write_b128 v9, v[40:43] offset:24576
s_waitcnt vmcnt(10)
v_mfma_f32_16x16x32_bf16 v[56:59], v[96:99], v[220:223], v[56:59]
v_mfma_f32_16x16x32_bf16 v[60:63], v[100:103], v[220:223], v[60:63]
ds_write_b128 v9, v[44:47] offset:28672
v_mfma_f32_16x16x32_bf16 v[64:67], v[104:107], v[220:223], v[64:67]
v_mfma_f32_16x16x32_bf16 v[68:71], v[108:111], v[220:223], v[68:71]
ds_write_b128 v9, v[48:51] offset:32768
v_mfma_f32_16x16x32_bf16 v[72:75], v[112:115], v[220:223], v[72:75]
s_waitcnt vmcnt(5)
v_mfma_f32_16x16x32_bf16 v[56:59], v[116:119], v[236:239], v[56:59]
ds_write_b128 v9, v[52:55] offset:36864
v_mfma_f32_16x16x32_bf16 v[60:63], v[120:123], v[236:239], v[60:63]
v_mfma_f32_16x16x32_bf16 v[64:67], v[124:127], v[236:239], v[64:67]
v_mfma_f32_16x16x32_bf16 v[68:71], v[128:131], v[236:239], v[68:71]
v_mfma_f32_16x16x32_bf16 v[72:75], v[132:135], v[236:239], v[72:75]
s_waitcnt vmcnt(18)
v_mfma_f32_16x16x32_bf16 v[76:79], v[136:139], v[208:211], v[76:79]
v_mfma_f32_16x16x32_bf16 v[80:83], v[140:143], v[208:211], v[80:83]
v_mfma_f32_16x16x32_bf16 v[84:87], v[144:147], v[208:211], v[84:87]
ds_write_b128 v9, v[56:59] offset:40960
v_mfma_f32_16x16x32_bf16 v[88:91], v[148:151], v[208:211], v[88:91]
v_mfma_f32_16x16x32_bf16 v[92:95], v[152:155], v[208:211], v[92:95]
ds_write_b128 v9, v[60:63] offset:45056
s_waitcnt vmcnt(9)
v_mfma_f32_16x16x32_bf16 v[76:79], v[96:99], v[224:227], v[76:79]
v_mfma_f32_16x16x32_bf16 v[80:83], v[100:103], v[224:227], v[80:83]
ds_write_b128 v9, v[64:67] offset:49152
v_mfma_f32_16x16x32_bf16 v[84:87], v[104:107], v[224:227], v[84:87]
v_mfma_f32_16x16x32_bf16 v[88:91], v[108:111], v[224:227], v[88:91]
ds_write_b128 v9, v[68:71] offset:53248
v_mfma_f32_16x16x32_bf16 v[92:95], v[112:115], v[224:227], v[92:95]
s_waitcnt vmcnt(4)
v_mfma_f32_16x16x32_bf16 v[76:79], v[116:119], v[240:243], v[76:79]
ds_write_b128 v9, v[72:75] offset:57344
v_mfma_f32_16x16x32_bf16 v[80:83], v[120:123], v[240:243], v[80:83]
v_mfma_f32_16x16x32_bf16 v[84:87], v[124:127], v[240:243], v[84:87]
v_mfma_f32_16x16x32_bf16 v[88:91], v[128:131], v[240:243], v[88:91]
v_mfma_f32_16x16x32_bf16 v[92:95], v[132:135], v[240:243], v[92:95]
s_add_u32 s73, s66, 1
s_and_b32 s73, s73, 3
s_mul_i32 s73, s73, 1024
v_add_u32 v2, s73, v1
s_add_u32 s73, s66, 2
s_and_b32 s73, s73, 3
s_mul_i32 s73, s73, 1024
v_add_u32 v3, s73, v1
s_add_u32 s73, s66, 3
s_and_b32 s73, s73, 3
s_mul_i32 s73, s73, 1024
v_add_u32 v4, s73, v1
v_lshrrev_b32 v11, 5, v0
v_mul_u32_u24 v11, 1024, v11
v_bfe_u32 v12, v0, 2, 3
v_mul_u32_u24 v12, 128, v12
v_add_u32 v11, v11, v12
v_and_b32 v12, 3, v0
v_lshl_add_u32 v11, v12, 3, v11
s_lshl_b32 s73, s66, 5
s_add_u32 s73, s73, 61440
v_add_u32 v11, s73, v11
s_cmp_eq_u32 s30, 0
s_cbranch_scc1 L_aok_52
s_mov_b32 s73, 10791
L_poll_53:
buffer_load_dword v12, v13, s[24:27], 0 offen sc1
s_waitcnt vmcnt(0)
v_cmp_ne_u32 vcc, s1, v12
s_cbranch_vccz L_pollok_54
s_sleep 8
s_sub_u32 s73, s73, 1
s_cbranch_scc0 L_poll_53
L_pollok_54:
v_lshlrev_b32 v14, 3, v8
buffer_load_dwordx2 v[14:15], v14, s[16:19], 0 offen sc1
buffer_load_dwordx4 v[244:247], v7, s[12:15], s70 offen sc1
buffer_load_dwordx4 v[248:251], v7, s[12:15], s71 offen sc1
buffer_load_dwordx4 v[252:255], v7, s[12:15], s72 offen sc1
L_aok_52:
s_waitcnt vmcnt(0)
ds_write_b128 v6, v[244:247] offset:0
ds_write_b128 v6, v[248:251] offset:4096
ds_write_b128 v6, v[252:255] offset:8192
s_waitcnt lgkmcnt(0)
s_barrier
ds_read_b128 v[96:99], v2 offset:40960
ds_read_b128 v[100:103], v2 offset:45056
ds_read_b128 v[104:107], v2 offset:49152
ds_read_b128 v[108:111], v2 offset:53248
ds_read_b128 v[112:115], v2 offset:57344
ds_read_b128 v[116:119], v3 offset:20480
ds_read_b128 v[120:123], v3 offset:24576
ds_read_b128 v[124:127], v3 offset:28672
ds_read_b128 v[128:131], v3 offset:32768
ds_read_b128 v[132:135], v3 offset:36864
ds_read_b128 v[136:139], v4 offset:0
ds_read_b128 v[140:143], v4 offset:4096
ds_read_b128 v[144:147], v4 offset:8192
ds_read_b128 v[148:151], v4 offset:12288
ds_read_b128 v[152:155], v4 offset:16384
ds_read_b64_tr_b16 v[196:197], v11 offset:0
ds_read_b64_tr_b16 v[198:199], v11 offset:2048
ds_read_b64_tr_b16 v[200:201], v11 offset:4096
ds_read_b64_tr_b16 v[202:203], v11 offset:6144
ds_read_b64_tr_b16 v[204:205], v11 offset:8192
v_mul_u32_u24 v5, 1280, v8
v_lshrrev_b32 v6, 4, v0
v_and_b32 v7, 1, v6
v_lshrrev_b32 v9, 1, v6
v_lshlrev_b32 v7, 5, v7
v_lshl_add_u32 v7, v9, 4, v7
v_add_u32 v7, v5, v7
v_lshl_add_u32 v6, v6, 3, v5
s_mul_i32 s73, s69, 160
s_waitcnt lgkmcnt(15)
v_add_f32 v76, v76, v96
v_add_f32 v77, v77, v97
v_add_f32 v78, v78, v98
v_add_f32 v79, v79, v99
v_add_f32 v80, v80, v100
v_add_f32 v81, v81, v101
v_add_f32 v82, v82, v102
v_add_f32 v83, v83, v103
v_add_f32 v84, v84, v104
v_add_f32 v85, v85, v105
v_add_f32 v86, v86, v106
v_add_f32 v87, v87, v107
v_add_f32 v88, v88, v108
v_add_f32 v89, v89, v109
v_add_f32 v90, v90, v110
v_add_f32 v91, v91, v111
v_add_f32 v92, v92, v112
v_add_f32 v93, v93, v113
v_add_f32 v94, v94, v114
v_add_f32 v95, v95, v115
s_waitcnt lgkmcnt(10)
v_add_f32 v76, v76, v116
v_add_f32 v77, v77, v117
v_add_f32 v78, v78, v118
v_add_f32 v79, v79, v119
v_add_f32 v80, v80, v120
v_add_f32 v81, v81, v121
v_add_f32 v82, v82, v122
v_add_f32 v83, v83, v123
v_add_f32 v84, v84, v124
v_add_f32 v85, v85, v125
v_add_f32 v86, v86, v126
v_add_f32 v87, v87, v127
v_add_f32 v88, v88, v128
v_add_f32 v89, v89, v129
v_add_f32 v90, v90, v130
v_add_f32 v91, v91, v131
v_add_f32 v92, v92, v132
v_add_f32 v93, v93, v133
v_add_f32 v94, v94, v134
v_add_f32 v95, v95, v135
s_waitcnt lgkmcnt(5)
v_add_f32 v76, v76, v136
v_add_f32 v77, v77, v137
v_add_f32 v78, v78, v138
v_add_f32 v79, v79, v139
v_add_f32 v80, v80, v140
v_add_f32 v81, v81, v141
v_add_f32 v82, v82, v142
v_add_f32 v83, v83, v143
v_add_f32 v84, v84, v144
v_add_f32 v85, v85, v145
v_add_f32 v86, v86, v146
v_add_f32 v87, v87, v147
v_add_f32 v88, v88, v148
v_add_f32 v89, v89, v149
v_add_f32 v90, v90, v150
v_add_f32 v91, v91, v151
v_add_f32 v92, v92, v152
v_add_f32 v93, v93, v153
v_add_f32 v94, v94, v154
v_add_f32 v95, v95, v155
s_waitcnt lgkmcnt(0)
v_lshlrev_b32 v12, 16, v196
v_and_b32 v13, 0xffff0000, v196
v_mul_f32 v76, v15, v76
v_mul_f32 v77, v15, v77
v_fmac_f32 v76, v14, v12
v_fmac_f32 v77, v14, v13
v_cvt_pk_bf16_f32 v212, v76, v77
v_lshlrev_b32 v12, 16, v197
v_and_b32 v13, 0xffff0000, v197
v_mul_f32 v78, v15, v78
v_mul_f32 v79, v15, v79
v_fmac_f32 v78, v14, v12
v_fmac_f32 v79, v14, v13
v_cvt_pk_bf16_f32 v213, v78, v79
v_lshlrev_b32 v12, 16, v198
v_and_b32 v13, 0xffff0000, v198
v_mul_f32 v80, v15, v80
v_mul_f32 v81, v15, v81
v_fmac_f32 v80, v14, v12
v_fmac_f32 v81, v14, v13
v_cvt_pk_bf16_f32 v214, v80, v81
v_lshlrev_b32 v12, 16, v199
v_and_b32 v13, 0xffff0000, v199
v_mul_f32 v82, v15, v82
v_mul_f32 v83, v15, v83
v_fmac_f32 v82, v14, v12
v_fmac_f32 v83, v14, v13
v_cvt_pk_bf16_f32 v215, v82, v83
v_permlane16_swap_b32 v212, v214
s_nop 0
v_permlane16_swap_b32 v213, v215
buffer_store_dwordx4 v[212:215], v7, s[20:23], s73 offen offset:0
v_lshlrev_b32 v12, 16, v200
v_and_b32 v13, 0xffff0000, v200
v_mul_f32 v84, v15, v84
v_mul_f32 v85, v15, v85
v_fmac_f32 v84, v14, v12
v_fmac_f32 v85, v14, v13
v_cvt_pk_bf16_f32 v216, v84, v85
v_lshlrev_b32 v12, 16, v201
v_and_b32 v13, 0xffff0000, v201
v_mul_f32 v86, v15, v86
v_mul_f32 v87, v15, v87
v_fmac_f32 v86, v14, v12
v_fmac_f32 v87, v14, v13
v_cvt_pk_bf16_f32 v217, v86, v87
v_lshlrev_b32 v12, 16, v202
v_and_b32 v13, 0xffff0000, v202
v_mul_f32 v88, v15, v88
v_mul_f32 v89, v15, v89
v_fmac_f32 v88, v14, v12
v_fmac_f32 v89, v14, v13
v_cvt_pk_bf16_f32 v218, v88, v89
v_lshlrev_b32 v12, 16, v203
v_and_b32 v13, 0xffff0000, v203
v_mul_f32 v90, v15, v90
v_mul_f32 v91, v15, v91
v_fmac_f32 v90, v14, v12
v_fmac_f32 v91, v14, v13
v_cvt_pk_bf16_f32 v219, v90, v91
v_permlane16_swap_b32 v216, v218
s_nop 0
v_permlane16_swap_b32 v217, v219
buffer_store_dwordx4 v[216:219], v7, s[20:23], s73 offen offset:64
v_lshlrev_b32 v12, 16, v204
v_and_b32 v13, 0xffff0000, v204
v_mul_f32 v92, v15, v92
v_mul_f32 v93, v15, v93
v_fmac_f32 v92, v14, v12
v_fmac_f32 v93, v14, v13
v_cvt_pk_bf16_f32 v220, v92, v93
v_lshlrev_b32 v12, 16, v205
v_and_b32 v13, 0xffff0000, v205
v_mul_f32 v94, v15, v94
v_mul_f32 v95, v15, v95
v_fmac_f32 v94, v14, v12
v_fmac_f32 v95, v14, v13
v_cvt_pk_bf16_f32 v221, v94, v95
buffer_store_dwordx2 v[220:221], v6, s[20:23], s73 offen offset:128
L_done:
L_exit:
s_endpgm
L_end:
.section .rodata,"a"
.p2align 6
.amdhsa_kernel gated_mix__ssm_conv_s4d__geglu_ffn__prompt_kernel
  .amdhsa_next_free_vgpr 256
  .amdhsa_next_free_sgpr 102
  .amdhsa_accum_offset 256
  .amdhsa_group_segment_fixed_size 0
  .amdhsa_kernarg_size 120
  .amdhsa_user_sgpr_count 2
  .amdhsa_user_sgpr_kernarg_segment_ptr 1
  .amdhsa_system_sgpr_workgroup_id_x 1
.end_amdhsa_kernel
```
